```python
import torch

def _softmax(x, axis=-1):
    return torch.softmax(x, dim=axis)
def _gelu(x):
    return torch.nn.functional.gelu(x, approximate="tanh")
def _silu(x):
    return torch.nn.functional.silu(x)
def _sigmoid(x):
    return torch.sigmoid(x)
def _layernorm(x, axis=-1, eps=1e-5):
    m = x.mean(dim=axis, keepdim=True)
    v = x.var(dim=axis, keepdim=True, unbiased=False)
    return (x - m) / torch.sqrt(v + eps)
def _scatter_add(tgt, idx, src, axis=0):
    return tgt.clone().index_add_(axis, idx, src)
def _segment_sum(src, seg, n):
    out = torch.zeros((n,) + src.shape[1:], dtype=src.dtype)
    return out.index_add_(0, seg, src)
def _pad(x, pw):
    flat = tuple(v for pair in reversed(pw) for v in pair)
    return torch.nn.functional.pad(x, flat)

kernel_name = 'standalone__layernorm_linear__sampling'

def setup_inputs():

    _w = (lambda a: (lambda t: t.to(torch.bfloat16) if t.is_floating_point() else t)(torch.as_tensor(a)))
    B, S, D = 1024, 16, 448
    return {
        "x": _w((lambda *s: torch.randn(*s, dtype=torch.bfloat16) * 0.05)(B, S, D)),
        "g": _w((lambda *s: torch.randn(*s, dtype=torch.bfloat16) * 0.05)(D) + 1.0),
        "b": _w((lambda *s: torch.randn(*s, dtype=torch.bfloat16) * 0.4)(D)),
        "w": _w((lambda *s: torch.randn(*s, dtype=torch.bfloat16) * 0.05)(D, D)),
    }

def reference(x, g, b, w):
    return (_layernorm(x, axis=-1) * g + b) @ w
```

```asm
; @launch grid=(256,1,1) block=(512,1,1) lds=163840
.amdgcn_target "amdgcn-amd-amdhsa--gfx950"
.text
.globl standalone__layernorm_linear__sampling_kernel
.p2align 8
.type standalone__layernorm_linear__sampling_kernel,@function
standalone__layernorm_linear__sampling_kernel:
    s_cmp_ge_u32 s2, 256
    s_cbranch_scc1 L_end
    s_load_dwordx8 s[4:11], s[0:1], 0
    s_load_dwordx2 s[12:13], s[0:1], 32
    s_getpc_b64 s[54:55]
L_pc:
    s_and_b32 s3, s2, 0xf8
    s_lshl_b32 s3, s3, 6
    v_and_b32 v2, 0x1c0, v0
    v_add_u32 v2, s3, v2
    v_min_u32 v2, L_end-L_pc, v2
    v_mov_b32 v3, s55
    v_add_co_u32 v2, vcc, s54, v2
    s_nop 1
    v_addc_co_u32 v3, vcc, 0, v3, vcc
    global_load_dword v255, v[2:3], off
    v_lshrrev_b32 v1, 6, v0
    v_and_b32 v0, 63, v0
    v_readfirstlane_b32 s40, v1
    v_lshrrev_b32 v10, 3, v0
    v_and_b32 v11, 7, v0
    v_lshlrev_b32 v11, 4, v11
    v_mul_u32_u24 v1, 896, v10
    v_add_u32 v1, v1, v11
    v_lshlrev_b32 v2, 4, v0
    s_lshr_b32 s45, s2, 4
    s_lshl_b32 s45, s45, 3
    s_and_b32 s47, s2, 7
    s_add_u32 s45, s45, s47
    s_mul_i32 s43, s45, 114688
    s_mul_i32 s45, s40, 7168
    s_add_u32 s41, s43, s45
    s_mov_b32 s18, 14680064
    s_mov_b32 s19, 0x20000
    s_mov_b32 s30, 896
    s_mov_b32 s31, 0x20000
    s_cmp_lg_u32 s40, 0
    s_waitcnt lgkmcnt(0)
    s_cbranch_scc1 L_nogb
    s_mov_b32 s28, s6
    s_and_b32 s29, s7, 0xffff
    buffer_load_dwordx4 v[240:243], v2, s[28:31], 0 offen
    s_mov_b32 s32, s8
    s_and_b32 s33, s9, 0xffff
    s_mov_b32 s34, 896
    s_mov_b32 s35, 0x20000
    buffer_load_dwordx4 v[244:247], v2, s[32:35], 0 offen
L_nogb:
    s_mov_b32 s16, s4
    s_and_b32 s17, s5, 0xffff
    buffer_load_dwordx4 v[16:19], v1, s[16:19], s41 offen offset:0 nt
    buffer_load_dwordx4 v[20:23], v1, s[16:19], s41 offen offset:128 nt
    buffer_load_dwordx4 v[24:27], v1, s[16:19], s41 offen offset:256 nt
    buffer_load_dwordx4 v[28:31], v1, s[16:19], s41 offen offset:384 nt
    buffer_load_dwordx4 v[32:35], v1, s[16:19], s41 offen offset:512 nt
    buffer_load_dwordx4 v[36:39], v1, s[16:19], s41 offen offset:640 nt
    buffer_load_dwordx4 v[40:43], v1, s[16:19], s41 offen offset:768 nt
    s_setprio 1
    s_cmp_ge_u32 s40, 4
    s_cbranch_scc1 L_p0
    s_setprio 2
L_p0:
    s_add_u32 s50, s41, 57344
    s_mov_b32 s20, s10
    s_and_b32 s21, s11, 0xffff
    s_mov_b32 s22, 401408
    s_mov_b32 s23, 0x20000
    s_mov_b32 s24, s12
    s_and_b32 s25, s13, 0xffff
    s_mov_b32 s26, 14680064
    s_mov_b32 s27, 0x20000
    s_bfe_u32 s42, s2, 0x10003
    s_mul_i32 s42, s42, 448
    s_add_u32 s43, s43, s42
    s_and_b32 s49, s2, 0xf8
    s_add_u32 s49, s49, s40
    s_mul_i32 s49, s49, 1568
    v_mul_u32_u24 v3, 928, v10
    v_add_u32 v3, v3, v11
    s_mul_i32 s45, s40, 7424
    v_add_u32 v3, s45, v3
    v_lshlrev_b32 v4, 1, v11
    v_add_u32 v4, 147456, v4
    v_and_b32 v10, 15, v0
    v_lshrrev_b32 v11, 4, v0
    v_mul_u32_u24 v7, 928, v10
    v_lshl_add_u32 v7, v11, 4, v7
    v_add_u32 v8, 59392, v7
    s_cmp_gt_u32 s40, 3
    s_subb_u32 s45, s40, 0
    s_lshl_b32 s45, s45, 6
    s_add_u32 s45, s45, 118784
    s_sub_u32 s47, s45, 118784
    s_add_u32 s43, s43, s47
    s_mul_i32 s46, s40, 5120
    s_add_u32 s46, s46, 118784
    v_mul_u32_u24 v9, 80, v10
    v_lshl_add_u32 v9, v11, 3, v9
    v_add_u32 v9, s46, v9
    v_lshrrev_b32 v12, 2, v0
    v_and_b32 v13, 3, v0
    v_mul_u32_u24 v252, 80, v12
    v_lshl_add_u32 v252, v13, 4, v252
    v_add_u32 v252, s46, v252
    v_mul_u32_u24 v253, 896, v12
    v_lshl_add_u32 v253, v13, 4, v253
    v_lshrrev_b32 v12, 2, v0
    v_mul_u32_u24 v5, 448, v12
    v_and_b32 v12, 3, v0
    v_lshl_add_u32 v5, v12, 3, v5
    v_add_u32 v5, s45, v5
    v_and_b32 v11, 1, v11
    v_lshlrev_b32 v11, 5, v11
    v_sub_u32 v6, v5, v11
    v_add_u32 v6, 32, v6
    v_add_u32 v5, v5, v11
    s_cmp_lg_u32 s40, 3
    s_cbranch_scc1 L_nosw
    s_movk_i32 s45, 448
    v_mul_u32_u24 v12, 2341, v0
    v_lshrrev_b32 v10, 16, v12
    v_add_u32 v11, 0, v2
    v_mad_u32_u24 v13, v10, s45, v11
    v_lshrrev_b32 v11, 2, v10
    v_mul_u32_u24 v11, 3584, v11
    v_and_b32 v10, 4, v10
    v_lshlrev_b32 v10, 3, v10
    v_xor_b32 v10, v10, v13
    v_add_u32 v5, v10, v11
    v_add_u32 v10, 149824, v12
    v_lshrrev_b32 v10, 16, v10
    v_add_u32 v11, 1024, v2
    v_mad_u32_u24 v13, v10, s45, v11
    v_lshrrev_b32 v11, 2, v10
    v_mul_u32_u24 v11, 3584, v11
    v_and_b32 v10, 4, v10
    v_lshlrev_b32 v10, 3, v10
    v_xor_b32 v10, v10, v13
    v_add_u32 v6, v10, v11
    v_subrev_u32 v6, 1024, v6
    v_add_u32 v10, 299648, v12
    v_lshrrev_b32 v10, 16, v10
    v_add_u32 v11, 2048, v2
    v_mad_u32_u24 v13, v10, s45, v11
    v_lshrrev_b32 v11, 2, v10
    v_mul_u32_u24 v11, 3584, v11
    v_and_b32 v10, 4, v10
    v_lshlrev_b32 v10, 3, v10
    v_xor_b32 v10, v10, v13
    v_add_u32 v7, v10, v11
    v_subrev_u32 v7, 2048, v7
    v_add_u32 v10, 449472, v12
    v_lshrrev_b32 v10, 16, v10
    v_add_u32 v11, 3072, v2
    v_mad_u32_u24 v13, v10, s45, v11
    v_lshrrev_b32 v11, 2, v10
    v_mul_u32_u24 v11, 3584, v11
    v_and_b32 v10, 4, v10
    v_lshlrev_b32 v10, 3, v10
    v_xor_b32 v10, v10, v13
    v_add_u32 v8, v10, v11
    v_subrev_u32 v8, 3072, v8
    v_add_u32 v10, 599296, v12
    v_lshrrev_b32 v10, 16, v10
    v_add_u32 v11, 4096, v2
    v_mad_u32_u24 v13, v10, s45, v11
    v_lshrrev_b32 v11, 2, v10
    v_mul_u32_u24 v11, 3584, v11
    v_and_b32 v10, 4, v10
    v_lshlrev_b32 v10, 3, v10
    v_xor_b32 v10, v10, v13
    v_add_u32 v9, v10, v11
    v_add_u32 v10, 749120, v12
    v_lshrrev_b32 v10, 16, v10
    v_add_u32 v11, 5120, v2
    v_mad_u32_u24 v13, v10, s45, v11
    v_lshrrev_b32 v11, 2, v10
    v_mul_u32_u24 v11, 3584, v11
    v_and_b32 v10, 4, v10
    v_lshlrev_b32 v10, 3, v10
    v_xor_b32 v10, v10, v13
    v_add_u32 v252, v10, v11
    v_subrev_u32 v252, 1024, v252
    v_add_u32 v10, 898944, v12
    v_lshrrev_b32 v10, 16, v10
    v_add_u32 v11, 6144, v2
    v_mad_u32_u24 v13, v10, s45, v11
    v_lshrrev_b32 v11, 2, v10
    v_mul_u32_u24 v11, 3584, v11
    v_and_b32 v10, 4, v10
    v_lshlrev_b32 v10, 3, v10
    v_xor_b32 v10, v10, v13
    v_add_u32 v253, v10, v11
    v_subrev_u32 v253, 2048, v253
L_nosw:
    v_mov_b32 v250, 0xffff0000
    v_mov_b32 v251, 0x3f803f80
    s_mov_b32 s44, 0x3727c5ac
    s_cmp_lg_u32 s40, 0
    s_cbranch_scc1 L_nogb2
    v_lshlrev_b32 v10, 5, v0
    v_add_u32 v10, 147456, v10
    s_waitcnt vmcnt(7)
    v_lshlrev_b32 v168, 16, v240
    v_and_b32 v169, v250, v240
    v_lshlrev_b32 v170, 16, v241
    v_and_b32 v171, v250, v241
    v_lshlrev_b32 v172, 16, v242
    v_and_b32 v173, v250, v242
    v_lshlrev_b32 v174, 16, v243
    v_and_b32 v175, v250, v243
    v_lshlrev_b32 v176, 16, v244
    v_and_b32 v177, v250, v244
    v_lshlrev_b32 v178, 16, v245
    v_and_b32 v179, v250, v245
    v_lshlrev_b32 v180, 16, v246
    v_and_b32 v181, v250, v246
    v_lshlrev_b32 v182, 16, v247
    v_and_b32 v183, v250, v247
    ds_write_b128 v10, v[168:171]
    ds_write_b128 v10, v[172:175] offset:16
    ds_write_b128 v10, v[176:179] offset:2048
    ds_write_b128 v10, v[180:183] offset:2064
    s_waitcnt lgkmcnt(0)
L_nogb2:
    s_barrier
    ds_read_b128 v[72:75], v4 offset:0
    ds_read_b128 v[76:79], v4 offset:16
    ds_read_b128 v[128:131], v4 offset:2048
    ds_read_b128 v[132:135], v4 offset:2064
    s_waitcnt vmcnt(6)
    buffer_load_dwordx4 v[44:47], v1, s[16:19], s50 offen offset:0 nt
    v_dot2_f32_bf16 v10, v251, v16, 0
    v_dot2_f32_bf16 v11, v16, v16, 0
    v_dot2_f32_bf16 v12, v251, v17, 0
    v_dot2_f32_bf16 v13, v17, v17, 0
    v_dot2c_f32_bf16 v10, v251, v18
    v_dot2c_f32_bf16 v11, v18, v18
    v_dot2c_f32_bf16 v12, v251, v19
    v_dot2c_f32_bf16 v13, v19, v19
    v_lshlrev_b32 v184, 16, v16
    v_and_b32 v185, v250, v16
    v_lshlrev_b32 v186, 16, v17
    v_and_b32 v187, v250, v17
    v_lshlrev_b32 v188, 16, v18
    v_and_b32 v189, v250, v18
    v_lshlrev_b32 v190, 16, v19
    v_and_b32 v191, v250, v19
    ds_read_b128 v[80:83], v4 offset:256
    ds_read_b128 v[84:87], v4 offset:272
    ds_read_b128 v[136:139], v4 offset:2304
    ds_read_b128 v[140:143], v4 offset:2320
    s_waitcnt vmcnt(6)
    buffer_load_dwordx4 v[48:51], v1, s[16:19], s50 offen offset:128 nt
    v_dot2c_f32_bf16 v10, v251, v20
    v_dot2c_f32_bf16 v11, v20, v20
    v_dot2c_f32_bf16 v12, v251, v21
    v_dot2c_f32_bf16 v13, v21, v21
    v_dot2c_f32_bf16 v10, v251, v22
    v_dot2c_f32_bf16 v11, v22, v22
    v_dot2c_f32_bf16 v12, v251, v23
    v_dot2c_f32_bf16 v13, v23, v23
    v_lshlrev_b32 v192, 16, v20
    v_and_b32 v193, v250, v20
    v_lshlrev_b32 v194, 16, v21
    v_and_b32 v195, v250, v21
    v_lshlrev_b32 v196, 16, v22
    v_and_b32 v197, v250, v22
    v_lshlrev_b32 v198, 16, v23
    v_and_b32 v199, v250, v23
    ds_read_b128 v[88:91], v4 offset:512
    ds_read_b128 v[92:95], v4 offset:528
    ds_read_b128 v[144:147], v4 offset:2560
    ds_read_b128 v[148:151], v4 offset:2576
    s_waitcnt vmcnt(6)
    buffer_load_dwordx4 v[52:55], v1, s[16:19], s50 offen offset:256 nt
    v_dot2c_f32_bf16 v10, v251, v24
    v_dot2c_f32_bf16 v11, v24, v24
    v_dot2c_f32_bf16 v12, v251, v25
    v_dot2c_f32_bf16 v13, v25, v25
    v_dot2c_f32_bf16 v10, v251, v26
    v_dot2c_f32_bf16 v11, v26, v26
    v_dot2c_f32_bf16 v12, v251, v27
    v_dot2c_f32_bf16 v13, v27, v27
    v_lshlrev_b32 v200, 16, v24
    v_and_b32 v201, v250, v24
    v_lshlrev_b32 v202, 16, v25
    v_and_b32 v203, v250, v25
    v_lshlrev_b32 v204, 16, v26
    v_and_b32 v205, v250, v26
    v_lshlrev_b32 v206, 16, v27
    v_and_b32 v207, v250, v27
    ds_read_b128 v[96:99], v4 offset:768
    ds_read_b128 v[100:103], v4 offset:784
    ds_read_b128 v[152:155], v4 offset:2816
    ds_read_b128 v[156:159], v4 offset:2832
    s_waitcnt vmcnt(6)
    buffer_load_dwordx4 v[56:59], v1, s[16:19], s50 offen offset:384 nt
    v_dot2c_f32_bf16 v10, v251, v28
    v_dot2c_f32_bf16 v11, v28, v28
    v_dot2c_f32_bf16 v12, v251, v29
    v_dot2c_f32_bf16 v13, v29, v29
    v_dot2c_f32_bf16 v10, v251, v30
    v_dot2c_f32_bf16 v11, v30, v30
    v_dot2c_f32_bf16 v12, v251, v31
    v_dot2c_f32_bf16 v13, v31, v31
    v_lshlrev_b32 v208, 16, v28
    v_and_b32 v209, v250, v28
    v_lshlrev_b32 v210, 16, v29
    v_and_b32 v211, v250, v29
    v_lshlrev_b32 v212, 16, v30
    v_and_b32 v213, v250, v30
    v_lshlrev_b32 v214, 16, v31
    v_and_b32 v215, v250, v31
    ds_read_b128 v[104:107], v4 offset:1024
    ds_read_b128 v[108:111], v4 offset:1040
    ds_read_b128 v[160:163], v4 offset:3072
    ds_read_b128 v[164:167], v4 offset:3088
    s_waitcnt vmcnt(6)
    buffer_load_dwordx4 v[60:63], v1, s[16:19], s50 offen offset:512 nt
    v_dot2c_f32_bf16 v10, v251, v32
    v_dot2c_f32_bf16 v11, v32, v32
    v_dot2c_f32_bf16 v12, v251, v33
    v_dot2c_f32_bf16 v13, v33, v33
    v_dot2c_f32_bf16 v10, v251, v34
    v_dot2c_f32_bf16 v11, v34, v34
    v_dot2c_f32_bf16 v12, v251, v35
    v_dot2c_f32_bf16 v13, v35, v35
    v_lshlrev_b32 v216, 16, v32
    v_and_b32 v217, v250, v32
    v_lshlrev_b32 v218, 16, v33
    v_and_b32 v219, v250, v33
    v_lshlrev_b32 v220, 16, v34
    v_and_b32 v221, v250, v34
    v_lshlrev_b32 v222, 16, v35
    v_and_b32 v223, v250, v35
    ds_read_b128 v[112:115], v4 offset:1280
    ds_read_b128 v[116:119], v4 offset:1296
    ds_read_b128 v[168:171], v4 offset:3328
    ds_read_b128 v[172:175], v4 offset:3344
    s_waitcnt vmcnt(6)
    buffer_load_dwordx4 v[64:67], v1, s[16:19], s50 offen offset:640 nt
    v_dot2c_f32_bf16 v10, v251, v36
    v_dot2c_f32_bf16 v11, v36, v36
    v_dot2c_f32_bf16 v12, v251, v37
    v_dot2c_f32_bf16 v13, v37, v37
    v_dot2c_f32_bf16 v10, v251, v38
    v_dot2c_f32_bf16 v11, v38, v38
    v_dot2c_f32_bf16 v12, v251, v39
    v_dot2c_f32_bf16 v13, v39, v39
    ds_read_b128 v[120:123], v4 offset:1536
    ds_read_b128 v[124:127], v4 offset:1552
    ds_read_b128 v[176:179], v4 offset:3584
    ds_read_b128 v[180:183], v4 offset:3600
    s_waitcnt vmcnt(6)
    buffer_load_dwordx4 v[68:71], v1, s[16:19], s50 offen offset:768 nt
    v_dot2c_f32_bf16 v10, v251, v40
    v_dot2c_f32_bf16 v11, v40, v40
    v_dot2c_f32_bf16 v12, v251, v41
    v_dot2c_f32_bf16 v13, v41, v41
    v_dot2c_f32_bf16 v10, v251, v42
    v_dot2c_f32_bf16 v11, v42, v42
    v_dot2c_f32_bf16 v12, v251, v43
    v_dot2c_f32_bf16 v13, v43, v43
    v_lshlrev_b32 v224, 16, v36
    v_and_b32 v225, v250, v36
    v_lshlrev_b32 v226, 16, v37
    v_add_f32 v10, v10, v12
    v_add_f32 v11, v11, v13
    v_and_b32 v227, v250, v37
    v_add_f32_dpp v10, v10, v10 quad_perm:[1,0,3,2] row_mask:0xf bank_mask:0xf
    v_add_f32_dpp v11, v11, v11 quad_perm:[1,0,3,2] row_mask:0xf bank_mask:0xf
    v_lshlrev_b32 v228, 16, v38
    v_add_f32_dpp v10, v10, v10 quad_perm:[2,3,0,1] row_mask:0xf bank_mask:0xf
    v_add_f32_dpp v11, v11, v11 quad_perm:[2,3,0,1] row_mask:0xf bank_mask:0xf
    v_and_b32 v229, v250, v38
    v_add_f32_dpp v10, v10, v10 row_half_mirror row_mask:0xf bank_mask:0xf
    v_add_f32_dpp v11, v11, v11 row_half_mirror row_mask:0xf bank_mask:0xf
    v_mul_f32 v12, 0x3b124925, v10
    v_lshlrev_b32 v230, 16, v39
    v_mul_f32 v10, -v12, v12
    v_and_b32 v231, v250, v39
    v_fmac_f32 v10, 0x3b124925, v11
    v_lshlrev_b32 v232, 16, v40
    v_max_f32 v11, 0, v10
    v_and_b32 v233, v250, v40
    v_cvt_pk_bf16_f32 v10, v12, v11
    v_lshlrev_b32 v234, 16, v41
    v_and_b32 v11, v250, v10
    v_lshlrev_b32 v12, 16, v10
    v_add_f32 v11, s44, v11
    v_and_b32 v235, v250, v41
    v_cvt_pk_bf16_f32 v11, v11, v11
    v_lshlrev_b32 v236, 16, v42
    v_and_b32 v11, v250, v11
    v_and_b32 v237, v250, v42
    v_sqrt_f32 v11, v11
    v_lshlrev_b32 v238, 16, v43
    v_cvt_pk_bf16_f32 v11, v11, v11
    v_and_b32 v11, v250, v11
    v_rcp_f32 v14, v11
    v_and_b32 v239, v250, v43
    v_mul_f32 v15, -v12, v14
    s_waitcnt lgkmcnt(0)
    v_pk_fma_f32 v[184:185], v[184:185], v[14:15], v[14:15] op_sel:[0,0,1] op_sel_hi:[1,0,1]
    v_pk_fma_f32 v[186:187], v[186:187], v[14:15], v[14:15] op_sel:[0,0,1] op_sel_hi:[1,0,1]
    v_pk_fma_f32 v[188:189], v[188:189], v[14:15], v[14:15] op_sel:[0,0,1] op_sel_hi:[1,0,1]
    v_pk_fma_f32 v[190:191], v[190:191], v[14:15], v[14:15] op_sel:[0,0,1] op_sel_hi:[1,0,1]
    v_pk_fma_f32 v[192:193], v[192:193], v[14:15], v[14:15] op_sel:[0,0,1] op_sel_hi:[1,0,1]
    v_pk_fma_f32 v[194:195], v[194:195], v[14:15], v[14:15] op_sel:[0,0,1] op_sel_hi:[1,0,1]
    v_pk_fma_f32 v[196:197], v[196:197], v[14:15], v[14:15] op_sel:[0,0,1] op_sel_hi:[1,0,1]
    v_pk_fma_f32 v[198:199], v[198:199], v[14:15], v[14:15] op_sel:[0,0,1] op_sel_hi:[1,0,1]
    v_pk_fma_f32 v[184:185], v[184:185], v[72:73], v[128:129]
    v_pk_fma_f32 v[186:187], v[186:187], v[74:75], v[130:131]
    v_pk_fma_f32 v[188:189], v[188:189], v[76:77], v[132:133]
    v_pk_fma_f32 v[190:191], v[190:191], v[78:79], v[134:135]
    v_pk_fma_f32 v[200:201], v[200:201], v[14:15], v[14:15] op_sel:[0,0,1] op_sel_hi:[1,0,1]
    v_pk_fma_f32 v[202:203], v[202:203], v[14:15], v[14:15] op_sel:[0,0,1] op_sel_hi:[1,0,1]
    v_pk_fma_f32 v[204:205], v[204:205], v[14:15], v[14:15] op_sel:[0,0,1] op_sel_hi:[1,0,1]
    v_pk_fma_f32 v[206:207], v[206:207], v[14:15], v[14:15] op_sel:[0,0,1] op_sel_hi:[1,0,1]
    v_pk_fma_f32 v[192:193], v[192:193], v[80:81], v[136:137]
    v_pk_fma_f32 v[194:195], v[194:195], v[82:83], v[138:139]
    v_pk_fma_f32 v[196:197], v[196:197], v[84:85], v[140:141]
    v_pk_fma_f32 v[198:199], v[198:199], v[86:87], v[142:143]
    v_cvt_pk_bf16_f32 v16, v184, v185
    v_cvt_pk_bf16_f32 v17, v186, v187
    v_cvt_pk_bf16_f32 v18, v188, v189
    v_cvt_pk_bf16_f32 v19, v190, v191
    ds_write_b128 v3, v[16:19] offset:0
    v_pk_fma_f32 v[208:209], v[208:209], v[14:15], v[14:15] op_sel:[0,0,1] op_sel_hi:[1,0,1]
    v_pk_fma_f32 v[210:211], v[210:211], v[14:15], v[14:15] op_sel:[0,0,1] op_sel_hi:[1,0,1]
    v_pk_fma_f32 v[212:213], v[212:213], v[14:15], v[14:15] op_sel:[0,0,1] op_sel_hi:[1,0,1]
    v_pk_fma_f32 v[214:215], v[214:215], v[14:15], v[14:15] op_sel:[0,0,1] op_sel_hi:[1,0,1]
    v_pk_fma_f32 v[200:201], v[200:201], v[88:89], v[144:145]
    v_pk_fma_f32 v[202:203], v[202:203], v[90:91], v[146:147]
    v_pk_fma_f32 v[204:205], v[204:205], v[92:93], v[148:149]
    v_pk_fma_f32 v[206:207], v[206:207], v[94:95], v[150:151]
    v_cvt_pk_bf16_f32 v20, v192, v193
    v_cvt_pk_bf16_f32 v21, v194, v195
    v_cvt_pk_bf16_f32 v22, v196, v197
    v_cvt_pk_bf16_f32 v23, v198, v199
    ds_write_b128 v3, v[20:23] offset:128
    v_pk_fma_f32 v[216:217], v[216:217], v[14:15], v[14:15] op_sel:[0,0,1] op_sel_hi:[1,0,1]
    v_pk_fma_f32 v[218:219], v[218:219], v[14:15], v[14:15] op_sel:[0,0,1] op_sel_hi:[1,0,1]
    v_pk_fma_f32 v[220:221], v[220:221], v[14:15], v[14:15] op_sel:[0,0,1] op_sel_hi:[1,0,1]
    v_pk_fma_f32 v[222:223], v[222:223], v[14:15], v[14:15] op_sel:[0,0,1] op_sel_hi:[1,0,1]
    v_pk_fma_f32 v[208:209], v[208:209], v[96:97], v[152:153]
    v_pk_fma_f32 v[210:211], v[210:211], v[98:99], v[154:155]
    v_pk_fma_f32 v[212:213], v[212:213], v[100:101], v[156:157]
    v_pk_fma_f32 v[214:215], v[214:215], v[102:103], v[158:159]
    v_cvt_pk_bf16_f32 v24, v200, v201
    v_cvt_pk_bf16_f32 v25, v202, v203
    v_cvt_pk_bf16_f32 v26, v204, v205
    v_cvt_pk_bf16_f32 v27, v206, v207
    ds_write_b128 v3, v[24:27] offset:256
    v_pk_fma_f32 v[224:225], v[224:225], v[14:15], v[14:15] op_sel:[0,0,1] op_sel_hi:[1,0,1]
    v_pk_fma_f32 v[226:227], v[226:227], v[14:15], v[14:15] op_sel:[0,0,1] op_sel_hi:[1,0,1]
    v_pk_fma_f32 v[228:229], v[228:229], v[14:15], v[14:15] op_sel:[0,0,1] op_sel_hi:[1,0,1]
    v_pk_fma_f32 v[230:231], v[230:231], v[14:15], v[14:15] op_sel:[0,0,1] op_sel_hi:[1,0,1]
    v_pk_fma_f32 v[216:217], v[216:217], v[104:105], v[160:161]
    v_pk_fma_f32 v[218:219], v[218:219], v[106:107], v[162:163]
    v_pk_fma_f32 v[220:221], v[220:221], v[108:109], v[164:165]
    v_pk_fma_f32 v[222:223], v[222:223], v[110:111], v[166:167]
    v_cvt_pk_bf16_f32 v28, v208, v209
    v_cvt_pk_bf16_f32 v29, v210, v211
    v_cvt_pk_bf16_f32 v30, v212, v213
    v_cvt_pk_bf16_f32 v31, v214, v215
    ds_write_b128 v3, v[28:31] offset:384
    v_pk_fma_f32 v[232:233], v[232:233], v[14:15], v[14:15] op_sel:[0,0,1] op_sel_hi:[1,0,1]
    v_pk_fma_f32 v[234:235], v[234:235], v[14:15], v[14:15] op_sel:[0,0,1] op_sel_hi:[1,0,1]
    v_pk_fma_f32 v[236:237], v[236:237], v[14:15], v[14:15] op_sel:[0,0,1] op_sel_hi:[1,0,1]
    v_pk_fma_f32 v[238:239], v[238:239], v[14:15], v[14:15] op_sel:[0,0,1] op_sel_hi:[1,0,1]
    v_pk_fma_f32 v[224:225], v[224:225], v[112:113], v[168:169]
    v_pk_fma_f32 v[226:227], v[226:227], v[114:115], v[170:171]
    v_pk_fma_f32 v[228:229], v[228:229], v[116:117], v[172:173]
    v_pk_fma_f32 v[230:231], v[230:231], v[118:119], v[174:175]
    v_cvt_pk_bf16_f32 v32, v216, v217
    v_cvt_pk_bf16_f32 v33, v218, v219
    v_cvt_pk_bf16_f32 v34, v220, v221
    v_cvt_pk_bf16_f32 v35, v222, v223
    ds_write_b128 v3, v[32:35] offset:512
    v_pk_fma_f32 v[232:233], v[232:233], v[120:121], v[176:177]
    v_pk_fma_f32 v[234:235], v[234:235], v[122:123], v[178:179]
    v_pk_fma_f32 v[236:237], v[236:237], v[124:125], v[180:181]
    v_pk_fma_f32 v[238:239], v[238:239], v[126:127], v[182:183]
    v_cvt_pk_bf16_f32 v36, v224, v225
    v_cvt_pk_bf16_f32 v37, v226, v227
    v_cvt_pk_bf16_f32 v38, v228, v229
    v_cvt_pk_bf16_f32 v39, v230, v231
    ds_write_b128 v3, v[36:39] offset:640
    v_cvt_pk_bf16_f32 v40, v232, v233
    v_cvt_pk_bf16_f32 v41, v234, v235
    v_cvt_pk_bf16_f32 v42, v236, v237
    v_cvt_pk_bf16_f32 v43, v238, v239
    ds_write_b128 v3, v[40:43] offset:768
    s_cmp_ge_u32 s40, 3
    s_cbranch_scc1 L_p1
    s_setprio 0
L_p1:
    s_waitcnt vmcnt(6)
    v_dot2_f32_bf16 v10, v251, v44, 0
    v_dot2_f32_bf16 v11, v44, v44, 0
    v_dot2_f32_bf16 v12, v251, v45, 0
    v_dot2_f32_bf16 v13, v45, v45, 0
    v_dot2c_f32_bf16 v10, v251, v46
    v_dot2c_f32_bf16 v11, v46, v46
    v_dot2c_f32_bf16 v12, v251, v47
    v_dot2c_f32_bf16 v13, v47, v47
    v_lshlrev_b32 v184, 16, v44
    v_and_b32 v185, v250, v44
    v_lshlrev_b32 v186, 16, v45
    v_and_b32 v187, v250, v45
    v_lshlrev_b32 v188, 16, v46
    v_and_b32 v189, v250, v46
    v_lshlrev_b32 v190, 16, v47
    v_and_b32 v191, v250, v47
    s_waitcnt vmcnt(5)
    v_dot2c_f32_bf16 v10, v251, v48
    v_dot2c_f32_bf16 v11, v48, v48
    v_dot2c_f32_bf16 v12, v251, v49
    v_dot2c_f32_bf16 v13, v49, v49
    v_dot2c_f32_bf16 v10, v251, v50
    v_dot2c_f32_bf16 v11, v50, v50
    v_dot2c_f32_bf16 v12, v251, v51
    v_dot2c_f32_bf16 v13, v51, v51
    v_lshlrev_b32 v192, 16, v48
    v_and_b32 v193, v250, v48
    v_lshlrev_b32 v194, 16, v49
    v_and_b32 v195, v250, v49
    v_lshlrev_b32 v196, 16, v50
    v_and_b32 v197, v250, v50
    v_lshlrev_b32 v198, 16, v51
    v_and_b32 v199, v250, v51
    s_waitcnt vmcnt(4)
    v_dot2c_f32_bf16 v10, v251, v52
    v_dot2c_f32_bf16 v11, v52, v52
    v_dot2c_f32_bf16 v12, v251, v53
    v_dot2c_f32_bf16 v13, v53, v53
    v_dot2c_f32_bf16 v10, v251, v54
    v_dot2c_f32_bf16 v11, v54, v54
    v_dot2c_f32_bf16 v12, v251, v55
    v_dot2c_f32_bf16 v13, v55, v55
    v_lshlrev_b32 v200, 16, v52
    v_and_b32 v201, v250, v52
    v_lshlrev_b32 v202, 16, v53
    v_and_b32 v203, v250, v53
    v_lshlrev_b32 v204, 16, v54
    v_and_b32 v205, v250, v54
    v_lshlrev_b32 v206, 16, v55
    v_and_b32 v207, v250, v55
    s_waitcnt vmcnt(3)
    buffer_load_dwordx4 v[240:243], v2, s[20:23], s49 offen
    s_mov_b32 exec_hi, 3
    buffer_load_dwordx4 v[244:247], v2, s[20:23], s49 offen offset:1024
    s_mov_b32 exec_hi, -1
    v_dot2c_f32_bf16 v10, v251, v56
    v_dot2c_f32_bf16 v11, v56, v56
    v_dot2c_f32_bf16 v12, v251, v57
    v_dot2c_f32_bf16 v13, v57, v57
    v_dot2c_f32_bf16 v10, v251, v58
    v_dot2c_f32_bf16 v11, v58, v58
    v_dot2c_f32_bf16 v12, v251, v59
    v_dot2c_f32_bf16 v13, v59, v59
    v_lshlrev_b32 v208, 16, v56
    v_and_b32 v209, v250, v56
    v_lshlrev_b32 v210, 16, v57
    v_and_b32 v211, v250, v57
    v_lshlrev_b32 v212, 16, v58
    v_and_b32 v213, v250, v58
    v_lshlrev_b32 v214, 16, v59
    v_and_b32 v215, v250, v59
    s_waitcnt vmcnt(4)
    v_dot2c_f32_bf16 v10, v251, v60
    v_dot2c_f32_bf16 v11, v60, v60
    v_dot2c_f32_bf16 v12, v251, v61
    v_dot2c_f32_bf16 v13, v61, v61
    v_dot2c_f32_bf16 v10, v251, v62
    v_dot2c_f32_bf16 v11, v62, v62
    v_dot2c_f32_bf16 v12, v251, v63
    v_dot2c_f32_bf16 v13, v63, v63
    v_lshlrev_b32 v216, 16, v60
    v_and_b32 v217, v250, v60
    v_lshlrev_b32 v218, 16, v61
    v_and_b32 v219, v250, v61
    v_lshlrev_b32 v220, 16, v62
    v_and_b32 v221, v250, v62
    v_lshlrev_b32 v222, 16, v63
    v_and_b32 v223, v250, v63
    s_waitcnt vmcnt(3)
    v_dot2c_f32_bf16 v10, v251, v64
    v_dot2c_f32_bf16 v11, v64, v64
    v_dot2c_f32_bf16 v12, v251, v65
    v_dot2c_f32_bf16 v13, v65, v65
    v_dot2c_f32_bf16 v10, v251, v66
    v_dot2c_f32_bf16 v11, v66, v66
    v_dot2c_f32_bf16 v12, v251, v67
    v_dot2c_f32_bf16 v13, v67, v67
    s_waitcnt vmcnt(2)
    v_dot2c_f32_bf16 v10, v251, v68
    v_dot2c_f32_bf16 v11, v68, v68
    v_dot2c_f32_bf16 v12, v251, v69
    v_dot2c_f32_bf16 v13, v69, v69
    v_dot2c_f32_bf16 v10, v251, v70
    v_dot2c_f32_bf16 v11, v70, v70
    v_dot2c_f32_bf16 v12, v251, v71
    v_dot2c_f32_bf16 v13, v71, v71
    v_lshlrev_b32 v224, 16, v64
    v_and_b32 v225, v250, v64
    v_lshlrev_b32 v226, 16, v65
    v_add_f32 v10, v10, v12
    v_add_f32 v11, v11, v13
    v_and_b32 v227, v250, v65
    v_add_f32_dpp v10, v10, v10 quad_perm:[1,0,3,2] row_mask:0xf bank_mask:0xf
    v_add_f32_dpp v11, v11, v11 quad_perm:[1,0,3,2] row_mask:0xf bank_mask:0xf
    v_lshlrev_b32 v228, 16, v66
    v_add_f32_dpp v10, v10, v10 quad_perm:[2,3,0,1] row_mask:0xf bank_mask:0xf
    v_add_f32_dpp v11, v11, v11 quad_perm:[2,3,0,1] row_mask:0xf bank_mask:0xf
    v_and_b32 v229, v250, v66
    v_add_f32_dpp v10, v10, v10 row_half_mirror row_mask:0xf bank_mask:0xf
    v_add_f32_dpp v11, v11, v11 row_half_mirror row_mask:0xf bank_mask:0xf
    v_mul_f32 v12, 0x3b124925, v10
    v_lshlrev_b32 v230, 16, v67
    v_mul_f32 v10, -v12, v12
    v_and_b32 v231, v250, v67
    v_fmac_f32 v10, 0x3b124925, v11
    v_lshlrev_b32 v232, 16, v68
    v_max_f32 v11, 0, v10
    v_and_b32 v233, v250, v68
    v_cvt_pk_bf16_f32 v10, v12, v11
    v_lshlrev_b32 v234, 16, v69
    v_and_b32 v11, v250, v10
    v_lshlrev_b32 v12, 16, v10
    v_add_f32 v11, s44, v11
    v_and_b32 v235, v250, v69
    v_cvt_pk_bf16_f32 v11, v11, v11
    v_lshlrev_b32 v236, 16, v70
    v_and_b32 v11, v250, v11
    v_and_b32 v237, v250, v70
    v_sqrt_f32 v11, v11
    v_lshlrev_b32 v238, 16, v71
    v_cvt_pk_bf16_f32 v11, v11, v11
    v_and_b32 v11, v250, v11
    v_rcp_f32 v14, v11
    v_and_b32 v239, v250, v71
    v_mul_f32 v15, -v12, v14
    s_cmp_lg_u32 s40, 3
    s_cbranch_scc1 L_nomid
    s_add_u32 m0, 118784, 0
    s_add_u32 s45, s42, 0
    buffer_load_dwordx4 v5, s[20:23], s45 offen offset:0 lds
    buffer_load_dwordx4 v6, s[20:23], s45 offen offset:1024 lds
    buffer_load_dwordx4 v7, s[20:23], s45 offen offset:2048 lds
    buffer_load_dwordx4 v8, s[20:23], s45 offen offset:3072 lds
    s_add_u32 m0, 122880, 0
    s_add_u32 s45, s42, 0
    buffer_load_dwordx4 v9, s[20:23], s45 offen offset:0 lds
    buffer_load_dwordx4 v252, s[20:23], s45 offen offset:1024 lds
    buffer_load_dwordx4 v253, s[20:23], s45 offen offset:2048 lds
    s_add_u32 m0, 125952, 0
    s_add_u32 s45, s42, 3584
    buffer_load_dwordx4 v5, s[20:23], s45 offen offset:0 lds
    buffer_load_dwordx4 v6, s[20:23], s45 offen offset:1024 lds
    buffer_load_dwordx4 v7, s[20:23], s45 offen offset:2048 lds
    buffer_load_dwordx4 v8, s[20:23], s45 offen offset:3072 lds
    s_add_u32 m0, 130048, 0
    s_add_u32 s45, s42, 3584
    buffer_load_dwordx4 v9, s[20:23], s45 offen offset:0 lds
    buffer_load_dwordx4 v252, s[20:23], s45 offen offset:1024 lds
    buffer_load_dwordx4 v253, s[20:23], s45 offen offset:2048 lds
    s_add_u32 m0, 133120, 0
    s_add_u32 s45, s42, 28672
    buffer_load_dwordx4 v5, s[20:23], s45 offen offset:0 lds
    buffer_load_dwordx4 v6, s[20:23], s45 offen offset:1024 lds
    buffer_load_dwordx4 v7, s[20:23], s45 offen offset:2048 lds
    buffer_load_dwordx4 v8, s[20:23], s45 offen offset:3072 lds
    s_add_u32 m0, 137216, 0
    s_add_u32 s45, s42, 28672
    buffer_load_dwordx4 v9, s[20:23], s45 offen offset:0 lds
    buffer_load_dwordx4 v252, s[20:23], s45 offen offset:1024 lds
    buffer_load_dwordx4 v253, s[20:23], s45 offen offset:2048 lds
    s_add_u32 m0, 140288, 0
    s_add_u32 s45, s42, 32256
    buffer_load_dwordx4 v5, s[20:23], s45 offen offset:0 lds
    buffer_load_dwordx4 v6, s[20:23], s45 offen offset:1024 lds
    buffer_load_dwordx4 v7, s[20:23], s45 offen offset:2048 lds
    buffer_load_dwordx4 v8, s[20:23], s45 offen offset:3072 lds
    s_add_u32 m0, 144384, 0
    s_add_u32 s45, s42, 32256
    buffer_load_dwordx4 v9, s[20:23], s45 offen offset:0 lds
    buffer_load_dwordx4 v252, s[20:23], s45 offen offset:1024 lds
    buffer_load_dwordx4 v253, s[20:23], s45 offen offset:2048 lds
    s_setprio 0
L_nomid:
    v_pk_fma_f32 v[184:185], v[184:185], v[14:15], v[14:15] op_sel:[0,0,1] op_sel_hi:[1,0,1]
    v_pk_fma_f32 v[186:187], v[186:187], v[14:15], v[14:15] op_sel:[0,0,1] op_sel_hi:[1,0,1]
    v_pk_fma_f32 v[188:189], v[188:189], v[14:15], v[14:15] op_sel:[0,0,1] op_sel_hi:[1,0,1]
    v_pk_fma_f32 v[190:191], v[190:191], v[14:15], v[14:15] op_sel:[0,0,1] op_sel_hi:[1,0,1]
    v_pk_fma_f32 v[192:193], v[192:193], v[14:15], v[14:15] op_sel:[0,0,1] op_sel_hi:[1,0,1]
    v_pk_fma_f32 v[194:195], v[194:195], v[14:15], v[14:15] op_sel:[0,0,1] op_sel_hi:[1,0,1]
    v_pk_fma_f32 v[196:197], v[196:197], v[14:15], v[14:15] op_sel:[0,0,1] op_sel_hi:[1,0,1]
    v_pk_fma_f32 v[198:199], v[198:199], v[14:15], v[14:15] op_sel:[0,0,1] op_sel_hi:[1,0,1]
    v_pk_fma_f32 v[184:185], v[184:185], v[72:73], v[128:129]
    v_pk_fma_f32 v[186:187], v[186:187], v[74:75], v[130:131]
    v_pk_fma_f32 v[188:189], v[188:189], v[76:77], v[132:133]
    v_pk_fma_f32 v[190:191], v[190:191], v[78:79], v[134:135]
    v_pk_fma_f32 v[200:201], v[200:201], v[14:15], v[14:15] op_sel:[0,0,1] op_sel_hi:[1,0,1]
    v_pk_fma_f32 v[202:203], v[202:203], v[14:15], v[14:15] op_sel:[0,0,1] op_sel_hi:[1,0,1]
    v_pk_fma_f32 v[204:205], v[204:205], v[14:15], v[14:15] op_sel:[0,0,1] op_sel_hi:[1,0,1]
    v_pk_fma_f32 v[206:207], v[206:207], v[14:15], v[14:15] op_sel:[0,0,1] op_sel_hi:[1,0,1]
    v_pk_fma_f32 v[192:193], v[192:193], v[80:81], v[136:137]
    v_pk_fma_f32 v[194:195], v[194:195], v[82:83], v[138:139]
    v_pk_fma_f32 v[196:197], v[196:197], v[84:85], v[140:141]
    v_pk_fma_f32 v[198:199], v[198:199], v[86:87], v[142:143]
    v_cvt_pk_bf16_f32 v44, v184, v185
    v_cvt_pk_bf16_f32 v45, v186, v187
    v_cvt_pk_bf16_f32 v46, v188, v189
    v_cvt_pk_bf16_f32 v47, v190, v191
    ds_write_b128 v3, v[44:47] offset:59392
    v_pk_fma_f32 v[208:209], v[208:209], v[14:15], v[14:15] op_sel:[0,0,1] op_sel_hi:[1,0,1]
    v_pk_fma_f32 v[210:211], v[210:211], v[14:15], v[14:15] op_sel:[0,0,1] op_sel_hi:[1,0,1]
    v_pk_fma_f32 v[212:213], v[212:213], v[14:15], v[14:15] op_sel:[0,0,1] op_sel_hi:[1,0,1]
    v_pk_fma_f32 v[214:215], v[214:215], v[14:15], v[14:15] op_sel:[0,0,1] op_sel_hi:[1,0,1]
    v_pk_fma_f32 v[200:201], v[200:201], v[88:89], v[144:145]
    v_pk_fma_f32 v[202:203], v[202:203], v[90:91], v[146:147]
    v_pk_fma_f32 v[204:205], v[204:205], v[92:93], v[148:149]
    v_pk_fma_f32 v[206:207], v[206:207], v[94:95], v[150:151]
    v_cvt_pk_bf16_f32 v48, v192, v193
    v_cvt_pk_bf16_f32 v49, v194, v195
    v_cvt_pk_bf16_f32 v50, v196, v197
    v_cvt_pk_bf16_f32 v51, v198, v199
    ds_write_b128 v3, v[48:51] offset:59520
    v_pk_fma_f32 v[216:217], v[216:217], v[14:15], v[14:15] op_sel:[0,0,1] op_sel_hi:[1,0,1]
    v_pk_fma_f32 v[218:219], v[218:219], v[14:15], v[14:15] op_sel:[0,0,1] op_sel_hi:[1,0,1]
    v_pk_fma_f32 v[220:221], v[220:221], v[14:15], v[14:15] op_sel:[0,0,1] op_sel_hi:[1,0,1]
    v_pk_fma_f32 v[222:223], v[222:223], v[14:15], v[14:15] op_sel:[0,0,1] op_sel_hi:[1,0,1]
    v_pk_fma_f32 v[208:209], v[208:209], v[96:97], v[152:153]
    v_pk_fma_f32 v[210:211], v[210:211], v[98:99], v[154:155]
    v_pk_fma_f32 v[212:213], v[212:213], v[100:101], v[156:157]
    v_pk_fma_f32 v[214:215], v[214:215], v[102:103], v[158:159]
    v_cvt_pk_bf16_f32 v52, v200, v201
    v_cvt_pk_bf16_f32 v53, v202, v203
    v_cvt_pk_bf16_f32 v54, v204, v205
    v_cvt_pk_bf16_f32 v55, v206, v207
    ds_write_b128 v3, v[52:55] offset:59648
    v_pk_fma_f32 v[224:225], v[224:225], v[14:15], v[14:15] op_sel:[0,0,1] op_sel_hi:[1,0,1]
    v_pk_fma_f32 v[226:227], v[226:227], v[14:15], v[14:15] op_sel:[0,0,1] op_sel_hi:[1,0,1]
    v_pk_fma_f32 v[228:229], v[228:229], v[14:15], v[14:15] op_sel:[0,0,1] op_sel_hi:[1,0,1]
    v_pk_fma_f32 v[230:231], v[230:231], v[14:15], v[14:15] op_sel:[0,0,1] op_sel_hi:[1,0,1]
    v_pk_fma_f32 v[216:217], v[216:217], v[104:105], v[160:161]
    v_pk_fma_f32 v[218:219], v[218:219], v[106:107], v[162:163]
    v_pk_fma_f32 v[220:221], v[220:221], v[108:109], v[164:165]
    v_pk_fma_f32 v[222:223], v[222:223], v[110:111], v[166:167]
    v_cvt_pk_bf16_f32 v56, v208, v209
    v_cvt_pk_bf16_f32 v57, v210, v211
    v_cvt_pk_bf16_f32 v58, v212, v213
    v_cvt_pk_bf16_f32 v59, v214, v215
    ds_write_b128 v3, v[56:59] offset:59776
    v_pk_fma_f32 v[232:233], v[232:233], v[14:15], v[14:15] op_sel:[0,0,1] op_sel_hi:[1,0,1]
    v_pk_fma_f32 v[234:235], v[234:235], v[14:15], v[14:15] op_sel:[0,0,1] op_sel_hi:[1,0,1]
    v_pk_fma_f32 v[236:237], v[236:237], v[14:15], v[14:15] op_sel:[0,0,1] op_sel_hi:[1,0,1]
    v_pk_fma_f32 v[238:239], v[238:239], v[14:15], v[14:15] op_sel:[0,0,1] op_sel_hi:[1,0,1]
    v_pk_fma_f32 v[224:225], v[224:225], v[112:113], v[168:169]
    v_pk_fma_f32 v[226:227], v[226:227], v[114:115], v[170:171]
    v_pk_fma_f32 v[228:229], v[228:229], v[116:117], v[172:173]
    v_pk_fma_f32 v[230:231], v[230:231], v[118:119], v[174:175]
    v_cvt_pk_bf16_f32 v60, v216, v217
    v_cvt_pk_bf16_f32 v61, v218, v219
    v_cvt_pk_bf16_f32 v62, v220, v221
    v_cvt_pk_bf16_f32 v63, v222, v223
    ds_write_b128 v3, v[60:63] offset:59904
    v_pk_fma_f32 v[232:233], v[232:233], v[120:121], v[176:177]
    v_pk_fma_f32 v[234:235], v[234:235], v[122:123], v[178:179]
    v_pk_fma_f32 v[236:237], v[236:237], v[124:125], v[180:181]
    v_pk_fma_f32 v[238:239], v[238:239], v[126:127], v[182:183]
    v_cvt_pk_bf16_f32 v64, v224, v225
    v_cvt_pk_bf16_f32 v65, v226, v227
    v_cvt_pk_bf16_f32 v66, v228, v229
    v_cvt_pk_bf16_f32 v67, v230, v231
    ds_write_b128 v3, v[64:67] offset:60032
    v_cvt_pk_bf16_f32 v68, v232, v233
    v_cvt_pk_bf16_f32 v69, v234, v235
    v_cvt_pk_bf16_f32 v70, v236, v237
    v_cvt_pk_bf16_f32 v71, v238, v239
    ds_write_b128 v3, v[68:71] offset:60160
    s_cmp_eq_u32 s40, 3
    s_cbranch_scc1 L_w7
    s_waitcnt lgkmcnt(0)
    s_setprio 0
    s_barrier
    ds_read_b128 v[176:179], v7 offset:0
    ds_read_b128 v[180:183], v7 offset:14848
    ds_read_b128 v[184:187], v7 offset:29696
    ds_read_b128 v[188:191], v7 offset:44544
    ds_read_b64_tr_b16 v[16:17], v5 offset:0
    ds_read_b64_tr_b16 v[18:19], v5 offset:7168
    ds_read_b64_tr_b16 v[20:21], v6 offset:0
    ds_read_b64_tr_b16 v[22:23], v6 offset:7168
    s_waitcnt lgkmcnt(0)
    v_mfma_f32_16x16x32_bf16 v[128:131], v[16:19], v[176:179], 0
    ds_read_b128 v[192:195], v7 offset:64
    v_mfma_f32_16x16x32_bf16 v[132:135], v[20:23], v[176:179], 0
    ds_read_b128 v[196:199], v7 offset:14912
    v_mfma_f32_16x16x32_bf16 v[136:139], v[16:19], v[180:183], 0
    ds_read_b128 v[200:203], v7 offset:29760
    v_mfma_f32_16x16x32_bf16 v[140:143], v[20:23], v[180:183], 0
    ds_read_b128 v[204:207], v7 offset:44608
    s_barrier
    v_mfma_f32_16x16x32_bf16 v[144:147], v[16:19], v[184:187], 0
    ds_read_b64_tr_b16 v[24:25], v5 offset:14336
    ds_read_b64_tr_b16 v[26:27], v5 offset:21504
    v_mfma_f32_16x16x32_bf16 v[148:151], v[20:23], v[184:187], 0
    ds_read_b64_tr_b16 v[28:29], v6 offset:14336
    ds_read_b64_tr_b16 v[30:31], v6 offset:21504
    v_mfma_f32_16x16x32_bf16 v[152:155], v[16:19], v[188:191], 0
    v_mfma_f32_16x16x32_bf16 v[156:159], v[20:23], v[188:191], 0
    s_waitcnt lgkmcnt(0)
    v_mfma_f32_16x16x32_bf16 v[128:131], v[24:27], v[192:195], v[128:131]
    ds_read_b128 v[176:179], v7 offset:128
    v_mfma_f32_16x16x32_bf16 v[132:135], v[28:31], v[192:195], v[132:135]
    ds_read_b128 v[180:183], v7 offset:14976
    v_mfma_f32_16x16x32_bf16 v[136:139], v[24:27], v[196:199], v[136:139]
    ds_read_b128 v[184:187], v7 offset:29824
    v_mfma_f32_16x16x32_bf16 v[140:143], v[28:31], v[196:199], v[140:143]
    ds_read_b128 v[188:191], v7 offset:44672
    s_barrier
    v_mfma_f32_16x16x32_bf16 v[144:147], v[24:27], v[200:203], v[144:147]
    ds_read_b64_tr_b16 v[32:33], v5 offset:28672
    ds_read_b64_tr_b16 v[34:35], v5 offset:35840
    v_mfma_f32_16x16x32_bf16 v[148:151], v[28:31], v[200:203], v[148:151]
    ds_read_b64_tr_b16 v[36:37], v6 offset:28672
    ds_read_b64_tr_b16 v[38:39], v6 offset:35840
    v_mfma_f32_16x16x32_bf16 v[152:155], v[24:27], v[204:207], v[152:155]
    v_mfma_f32_16x16x32_bf16 v[156:159], v[28:31], v[204:207], v[156:159]
    s_waitcnt lgkmcnt(0)
    v_mfma_f32_16x16x32_bf16 v[128:131], v[32:35], v[176:179], v[128:131]
    ds_read_b128 v[192:195], v7 offset:192
    v_mfma_f32_16x16x32_bf16 v[132:135], v[36:39], v[176:179], v[132:135]
    ds_read_b128 v[196:199], v7 offset:15040
    v_mfma_f32_16x16x32_bf16 v[136:139], v[32:35], v[180:183], v[136:139]
    ds_read_b128 v[200:203], v7 offset:29888
    v_mfma_f32_16x16x32_bf16 v[140:143], v[36:39], v[180:183], v[140:143]
    ds_read_b128 v[204:207], v7 offset:44736
    s_barrier
    v_mfma_f32_16x16x32_bf16 v[144:147], v[32:35], v[184:187], v[144:147]
    ds_read_b64_tr_b16 v[40:41], v5 offset:0
    ds_read_b64_tr_b16 v[42:43], v5 offset:7168
    v_mfma_f32_16x16x32_bf16 v[148:151], v[36:39], v[184:187], v[148:151]
    ds_read_b64_tr_b16 v[44:45], v6 offset:0
    ds_read_b64_tr_b16 v[46:47], v6 offset:7168
    v_mfma_f32_16x16x32_bf16 v[152:155], v[32:35], v[188:191], v[152:155]
    v_mfma_f32_16x16x32_bf16 v[156:159], v[36:39], v[188:191], v[156:159]
    s_waitcnt lgkmcnt(0)
    v_mfma_f32_16x16x32_bf16 v[128:131], v[40:43], v[192:195], v[128:131]
    ds_read_b128 v[176:179], v7 offset:256
    v_mfma_f32_16x16x32_bf16 v[132:135], v[44:47], v[192:195], v[132:135]
    ds_read_b128 v[180:183], v7 offset:15104
    v_mfma_f32_16x16x32_bf16 v[136:139], v[40:43], v[196:199], v[136:139]
    ds_read_b128 v[184:187], v7 offset:29952
    v_mfma_f32_16x16x32_bf16 v[140:143], v[44:47], v[196:199], v[140:143]
    ds_read_b128 v[188:191], v7 offset:44800
    s_barrier
    v_mfma_f32_16x16x32_bf16 v[144:147], v[40:43], v[200:203], v[144:147]
    ds_read_b64_tr_b16 v[48:49], v5 offset:14336
    ds_read_b64_tr_b16 v[50:51], v5 offset:21504
    v_mfma_f32_16x16x32_bf16 v[148:151], v[44:47], v[200:203], v[148:151]
    ds_read_b64_tr_b16 v[52:53], v6 offset:14336
    ds_read_b64_tr_b16 v[54:55], v6 offset:21504
    v_mfma_f32_16x16x32_bf16 v[152:155], v[40:43], v[204:207], v[152:155]
    v_mfma_f32_16x16x32_bf16 v[156:159], v[44:47], v[204:207], v[156:159]
    s_waitcnt lgkmcnt(0)
    v_mfma_f32_16x16x32_bf16 v[128:131], v[48:51], v[176:179], v[128:131]
    ds_read_b128 v[192:195], v7 offset:320
    v_mfma_f32_16x16x32_bf16 v[132:135], v[52:55], v[176:179], v[132:135]
    ds_read_b128 v[196:199], v7 offset:15168
    v_mfma_f32_16x16x32_bf16 v[136:139], v[48:51], v[180:183], v[136:139]
    ds_read_b128 v[200:203], v7 offset:30016
    v_mfma_f32_16x16x32_bf16 v[140:143], v[52:55], v[180:183], v[140:143]
    ds_read_b128 v[204:207], v7 offset:44864
    s_barrier
    v_mfma_f32_16x16x32_bf16 v[144:147], v[48:51], v[184:187], v[144:147]
    ds_read_b64_tr_b16 v[56:57], v5 offset:28672
    ds_read_b64_tr_b16 v[58:59], v5 offset:35840
    v_mfma_f32_16x16x32_bf16 v[148:151], v[52:55], v[184:187], v[148:151]
    ds_read_b64_tr_b16 v[60:61], v6 offset:28672
    ds_read_b64_tr_b16 v[62:63], v6 offset:35840
    v_mfma_f32_16x16x32_bf16 v[152:155], v[48:51], v[188:191], v[152:155]
    v_mfma_f32_16x16x32_bf16 v[156:159], v[52:55], v[188:191], v[156:159]
    s_waitcnt lgkmcnt(0)
    v_mfma_f32_16x16x32_bf16 v[128:131], v[56:59], v[192:195], v[128:131]
    ds_read_b128 v[176:179], v7 offset:384
    v_mfma_f32_16x16x32_bf16 v[132:135], v[60:63], v[192:195], v[132:135]
    ds_read_b128 v[180:183], v7 offset:15232
    v_mfma_f32_16x16x32_bf16 v[136:139], v[56:59], v[196:199], v[136:139]
    ds_read_b128 v[184:187], v7 offset:30080
    v_mfma_f32_16x16x32_bf16 v[140:143], v[60:63], v[196:199], v[140:143]
    ds_read_b128 v[188:191], v7 offset:44928
    s_barrier
    v_mfma_f32_16x16x32_bf16 v[144:147], v[56:59], v[200:203], v[144:147]
    ds_read_b64_tr_b16 v[64:65], v5 offset:0
    ds_read_b64_tr_b16 v[66:67], v5 offset:7168
    v_mfma_f32_16x16x32_bf16 v[148:151], v[60:63], v[200:203], v[148:151]
    ds_read_b64_tr_b16 v[68:69], v6 offset:0
    ds_read_b64_tr_b16 v[70:71], v6 offset:7168
    v_mfma_f32_16x16x32_bf16 v[152:155], v[56:59], v[204:207], v[152:155]
    v_mfma_f32_16x16x32_bf16 v[156:159], v[60:63], v[204:207], v[156:159]
    s_waitcnt lgkmcnt(0)
    v_mfma_f32_16x16x32_bf16 v[128:131], v[64:67], v[176:179], v[128:131]
    ds_read_b128 v[192:195], v7 offset:448
    v_mfma_f32_16x16x32_bf16 v[132:135], v[68:71], v[176:179], v[132:135]
    ds_read_b128 v[196:199], v7 offset:15296
    v_mfma_f32_16x16x32_bf16 v[136:139], v[64:67], v[180:183], v[136:139]
    ds_read_b128 v[200:203], v7 offset:30144
    v_mfma_f32_16x16x32_bf16 v[140:143], v[68:71], v[180:183], v[140:143]
    ds_read_b128 v[204:207], v7 offset:44992
    s_barrier
    v_mfma_f32_16x16x32_bf16 v[144:147], v[64:67], v[184:187], v[144:147]
    ds_read_b64_tr_b16 v[72:73], v5 offset:14336
    ds_read_b64_tr_b16 v[74:75], v5 offset:21504
    v_mfma_f32_16x16x32_bf16 v[148:151], v[68:71], v[184:187], v[148:151]
    ds_read_b64_tr_b16 v[76:77], v6 offset:14336
    ds_read_b64_tr_b16 v[78:79], v6 offset:21504
    v_mfma_f32_16x16x32_bf16 v[152:155], v[64:67], v[188:191], v[152:155]
    v_mfma_f32_16x16x32_bf16 v[156:159], v[68:71], v[188:191], v[156:159]
    s_waitcnt lgkmcnt(0)
    v_mfma_f32_16x16x32_bf16 v[128:131], v[72:75], v[192:195], v[128:131]
    ds_read_b128 v[176:179], v7 offset:512
    v_mfma_f32_16x16x32_bf16 v[132:135], v[76:79], v[192:195], v[132:135]
    ds_read_b128 v[180:183], v7 offset:15360
    v_mfma_f32_16x16x32_bf16 v[136:139], v[72:75], v[196:199], v[136:139]
    ds_read_b128 v[184:187], v7 offset:30208
    v_mfma_f32_16x16x32_bf16 v[140:143], v[76:79], v[196:199], v[140:143]
    ds_read_b128 v[188:191], v7 offset:45056
    s_barrier
    v_mfma_f32_16x16x32_bf16 v[144:147], v[72:75], v[200:203], v[144:147]
    ds_read_b64_tr_b16 v[80:81], v5 offset:28672
    ds_read_b64_tr_b16 v[82:83], v5 offset:35840
    v_mfma_f32_16x16x32_bf16 v[148:151], v[76:79], v[200:203], v[148:151]
    ds_read_b64_tr_b16 v[84:85], v6 offset:28672
    ds_read_b64_tr_b16 v[86:87], v6 offset:35840
    v_mfma_f32_16x16x32_bf16 v[152:155], v[72:75], v[204:207], v[152:155]
    v_mfma_f32_16x16x32_bf16 v[156:159], v[76:79], v[204:207], v[156:159]
    s_waitcnt lgkmcnt(0)
    v_mfma_f32_16x16x32_bf16 v[128:131], v[80:83], v[176:179], v[128:131]
    ds_read_b128 v[192:195], v7 offset:576
    v_mfma_f32_16x16x32_bf16 v[132:135], v[84:87], v[176:179], v[132:135]
    ds_read_b128 v[196:199], v7 offset:15424
    v_mfma_f32_16x16x32_bf16 v[136:139], v[80:83], v[180:183], v[136:139]
    ds_read_b128 v[200:203], v7 offset:30272
    v_mfma_f32_16x16x32_bf16 v[140:143], v[84:87], v[180:183], v[140:143]
    ds_read_b128 v[204:207], v7 offset:45120
    s_barrier
    v_mfma_f32_16x16x32_bf16 v[144:147], v[80:83], v[184:187], v[144:147]
    ds_read_b64_tr_b16 v[88:89], v5 offset:0
    ds_read_b64_tr_b16 v[90:91], v5 offset:7168
    v_mfma_f32_16x16x32_bf16 v[148:151], v[84:87], v[184:187], v[148:151]
    ds_read_b64_tr_b16 v[92:93], v6 offset:0
    ds_read_b64_tr_b16 v[94:95], v6 offset:7168
    v_mfma_f32_16x16x32_bf16 v[152:155], v[80:83], v[188:191], v[152:155]
    v_mfma_f32_16x16x32_bf16 v[156:159], v[84:87], v[188:191], v[156:159]
    s_waitcnt lgkmcnt(0)
    v_mfma_f32_16x16x32_bf16 v[128:131], v[88:91], v[192:195], v[128:131]
    ds_read_b128 v[176:179], v7 offset:640
    v_mfma_f32_16x16x32_bf16 v[132:135], v[92:95], v[192:195], v[132:135]
    ds_read_b128 v[180:183], v7 offset:15488
    v_mfma_f32_16x16x32_bf16 v[136:139], v[88:91], v[196:199], v[136:139]
    ds_read_b128 v[184:187], v7 offset:30336
    v_mfma_f32_16x16x32_bf16 v[140:143], v[92:95], v[196:199], v[140:143]
    ds_read_b128 v[188:191], v7 offset:45184
    s_barrier
    v_mfma_f32_16x16x32_bf16 v[144:147], v[88:91], v[200:203], v[144:147]
    ds_read_b64_tr_b16 v[96:97], v5 offset:14336
    ds_read_b64_tr_b16 v[98:99], v5 offset:21504
    v_mfma_f32_16x16x32_bf16 v[148:151], v[92:95], v[200:203], v[148:151]
    ds_read_b64_tr_b16 v[100:101], v6 offset:14336
    ds_read_b64_tr_b16 v[102:103], v6 offset:21504
    v_mfma_f32_16x16x32_bf16 v[152:155], v[88:91], v[204:207], v[152:155]
    v_mfma_f32_16x16x32_bf16 v[156:159], v[92:95], v[204:207], v[156:159]
    s_waitcnt lgkmcnt(0)
    v_mfma_f32_16x16x32_bf16 v[128:131], v[96:99], v[176:179], v[128:131]
    ds_read_b128 v[192:195], v7 offset:704
    v_mfma_f32_16x16x32_bf16 v[132:135], v[100:103], v[176:179], v[132:135]
    ds_read_b128 v[196:199], v7 offset:15552
    v_mfma_f32_16x16x32_bf16 v[136:139], v[96:99], v[180:183], v[136:139]
    ds_read_b128 v[200:203], v7 offset:30400
    v_mfma_f32_16x16x32_bf16 v[140:143], v[100:103], v[180:183], v[140:143]
    ds_read_b128 v[204:207], v7 offset:45248
    s_barrier
    v_mfma_f32_16x16x32_bf16 v[144:147], v[96:99], v[184:187], v[144:147]
    ds_read_b64_tr_b16 v[104:105], v5 offset:28672
    ds_read_b64_tr_b16 v[106:107], v5 offset:35840
    v_mfma_f32_16x16x32_bf16 v[148:151], v[100:103], v[184:187], v[148:151]
    ds_read_b64_tr_b16 v[108:109], v6 offset:28672
    ds_read_b64_tr_b16 v[110:111], v6 offset:35840
    v_mfma_f32_16x16x32_bf16 v[152:155], v[96:99], v[188:191], v[152:155]
    v_mfma_f32_16x16x32_bf16 v[156:159], v[100:103], v[188:191], v[156:159]
    s_waitcnt lgkmcnt(0)
    v_mfma_f32_16x16x32_bf16 v[128:131], v[104:107], v[192:195], v[128:131]
    ds_read_b128 v[176:179], v7 offset:768
    v_mfma_f32_16x16x32_bf16 v[132:135], v[108:111], v[192:195], v[132:135]
    ds_read_b128 v[180:183], v7 offset:15616
    v_mfma_f32_16x16x32_bf16 v[136:139], v[104:107], v[196:199], v[136:139]
    ds_read_b128 v[184:187], v7 offset:30464
    v_mfma_f32_16x16x32_bf16 v[140:143], v[108:111], v[196:199], v[140:143]
    ds_read_b128 v[188:191], v7 offset:45312
    s_barrier
    v_mfma_f32_16x16x32_bf16 v[144:147], v[104:107], v[200:203], v[144:147]
    ds_read_b64_tr_b16 v[112:113], v5 offset:0
    ds_read_b64_tr_b16 v[114:115], v5 offset:7168
    v_mfma_f32_16x16x32_bf16 v[148:151], v[108:111], v[200:203], v[148:151]
    ds_read_b64_tr_b16 v[116:117], v6 offset:0
    ds_read_b64_tr_b16 v[118:119], v6 offset:7168
    v_mfma_f32_16x16x32_bf16 v[152:155], v[104:107], v[204:207], v[152:155]
    v_mfma_f32_16x16x32_bf16 v[156:159], v[108:111], v[204:207], v[156:159]
    s_waitcnt lgkmcnt(0)
    v_mfma_f32_16x16x32_bf16 v[128:131], v[112:115], v[176:179], v[128:131]
    ds_read_b128 v[192:195], v7 offset:832
    v_mfma_f32_16x16x32_bf16 v[132:135], v[116:119], v[176:179], v[132:135]
    ds_read_b128 v[196:199], v7 offset:15680
    v_mfma_f32_16x16x32_bf16 v[136:139], v[112:115], v[180:183], v[136:139]
    ds_read_b128 v[200:203], v7 offset:30528
    v_mfma_f32_16x16x32_bf16 v[140:143], v[116:119], v[180:183], v[140:143]
    ds_read_b128 v[204:207], v7 offset:45376
    s_barrier
    v_mfma_f32_16x16x32_bf16 v[144:147], v[112:115], v[184:187], v[144:147]
    ds_read_b64_tr_b16 v[120:121], v5 offset:14336
    ds_read_b64_tr_b16 v[122:123], v5 offset:21504
    v_mfma_f32_16x16x32_bf16 v[148:151], v[116:119], v[184:187], v[148:151]
    ds_read_b64_tr_b16 v[124:125], v6 offset:14336
    ds_read_b64_tr_b16 v[126:127], v6 offset:21504
    v_mfma_f32_16x16x32_bf16 v[152:155], v[112:115], v[188:191], v[152:155]
    v_mfma_f32_16x16x32_bf16 v[156:159], v[116:119], v[188:191], v[156:159]
    s_waitcnt lgkmcnt(0)
    v_mfma_f32_16x16x32_bf16 v[128:131], v[120:123], v[192:195], v[128:131]
    ds_read_b128 v[176:179], v8 offset:0
    v_mfma_f32_16x16x32_bf16 v[132:135], v[124:127], v[192:195], v[132:135]
    ds_read_b128 v[180:183], v8 offset:64
    v_mfma_f32_16x16x32_bf16 v[136:139], v[120:123], v[196:199], v[136:139]
    ds_read_b128 v[184:187], v8 offset:128
    v_mfma_f32_16x16x32_bf16 v[140:143], v[124:127], v[196:199], v[140:143]
    ds_read_b128 v[188:191], v8 offset:192
    s_barrier
    v_mfma_f32_16x16x32_bf16 v[144:147], v[120:123], v[200:203], v[144:147]
    v_mfma_f32_16x16x32_bf16 v[148:151], v[124:127], v[200:203], v[148:151]
    v_mfma_f32_16x16x32_bf16 v[152:155], v[120:123], v[204:207], v[152:155]
    v_mfma_f32_16x16x32_bf16 v[156:159], v[124:127], v[204:207], v[156:159]
    s_waitcnt lgkmcnt(3)
    v_mfma_f32_16x16x32_bf16 v[160:163], v[16:19], v[176:179], 0
    ds_read_b128 v[192:195], v8 offset:256
    v_mfma_f32_16x16x32_bf16 v[164:167], v[20:23], v[176:179], 0
    s_waitcnt lgkmcnt(3)
    v_mfma_f32_16x16x32_bf16 v[160:163], v[24:27], v[180:183], v[160:163]
    ds_read_b128 v[196:199], v8 offset:320
    v_mfma_f32_16x16x32_bf16 v[164:167], v[28:31], v[180:183], v[164:167]
    v_cvt_pk_bf16_f32 v128, v128, v129
    s_waitcnt lgkmcnt(3)
    v_mfma_f32_16x16x32_bf16 v[160:163], v[32:35], v[184:187], v[160:163]
    ds_read_b128 v[200:203], v8 offset:384
    v_cvt_pk_bf16_f32 v129, v130, v131
    v_mfma_f32_16x16x32_bf16 v[164:167], v[36:39], v[184:187], v[164:167]
    ds_write_b64 v9, v[128:129] offset:0
    s_waitcnt lgkmcnt(4)
    v_mfma_f32_16x16x32_bf16 v[160:163], v[40:43], v[188:191], v[160:163]
    ds_read_b128 v[204:207], v8 offset:448
    v_cvt_pk_bf16_f32 v132, v132, v133
    v_mfma_f32_16x16x32_bf16 v[164:167], v[44:47], v[188:191], v[164:167]
    v_cvt_pk_bf16_f32 v133, v134, v135
    s_waitcnt lgkmcnt(4)
    v_mfma_f32_16x16x32_bf16 v[160:163], v[48:51], v[192:195], v[160:163]
    ds_read_b128 v[176:179], v8 offset:512
    ds_write_b64 v9, v[132:133] offset:32
    v_mfma_f32_16x16x32_bf16 v[164:167], v[52:55], v[192:195], v[164:167]
    v_cvt_pk_bf16_f32 v136, v136, v137
    s_waitcnt lgkmcnt(5)
    v_mfma_f32_16x16x32_bf16 v[160:163], v[56:59], v[196:199], v[160:163]
    ds_read_b128 v[180:183], v8 offset:576
    v_cvt_pk_bf16_f32 v137, v138, v139
    v_mfma_f32_16x16x32_bf16 v[164:167], v[60:63], v[196:199], v[164:167]
    ds_write_b64 v9, v[136:137] offset:1280
    s_waitcnt lgkmcnt(6)
    v_mfma_f32_16x16x32_bf16 v[160:163], v[64:67], v[200:203], v[160:163]
    ds_read_b128 v[184:187], v8 offset:640
    v_cvt_pk_bf16_f32 v140, v140, v141
    v_mfma_f32_16x16x32_bf16 v[164:167], v[68:71], v[200:203], v[164:167]
    v_cvt_pk_bf16_f32 v141, v142, v143
    s_waitcnt lgkmcnt(5)
    v_mfma_f32_16x16x32_bf16 v[160:163], v[72:75], v[204:207], v[160:163]
    ds_read_b128 v[188:191], v8 offset:704
    ds_write_b64 v9, v[140:141] offset:1312
    v_mfma_f32_16x16x32_bf16 v[164:167], v[76:79], v[204:207], v[164:167]
    s_waitcnt lgkmcnt(5)
    ds_read_b128 v[132:135], v252 offset:0
    v_mfma_f32_16x16x32_bf16 v[160:163], v[80:83], v[176:179], v[160:163]
    ds_read_b128 v[192:195], v8 offset:768
    v_cvt_pk_bf16_f32 v144, v144, v145
    v_mfma_f32_16x16x32_bf16 v[164:167], v[84:87], v[176:179], v[164:167]
    v_cvt_pk_bf16_f32 v145, v146, v147
    s_waitcnt lgkmcnt(6)
    v_mfma_f32_16x16x32_bf16 v[160:163], v[88:91], v[180:183], v[160:163]
    ds_read_b128 v[196:199], v8 offset:832
    ds_write_b64 v9, v[144:145] offset:2560
    v_mfma_f32_16x16x32_bf16 v[164:167], v[92:95], v[180:183], v[164:167]
    v_cvt_pk_bf16_f32 v148, v148, v149
    s_waitcnt lgkmcnt(6)
    v_mfma_f32_16x16x32_bf16 v[160:163], v[96:99], v[184:187], v[160:163]
    ds_read_b128 v[200:203], v8 offset:14848
    v_cvt_pk_bf16_f32 v149, v150, v151
    v_mfma_f32_16x16x32_bf16 v[164:167], v[100:103], v[184:187], v[164:167]
    ds_write_b64 v9, v[148:149] offset:2592
    s_waitcnt lgkmcnt(7)
    v_mfma_f32_16x16x32_bf16 v[160:163], v[104:107], v[188:191], v[160:163]
    ds_read_b128 v[204:207], v8 offset:14912
    s_waitcnt lgkmcnt(7)
    ds_read_b128 v[140:143], v252 offset:1280
    v_mfma_f32_16x16x32_bf16 v[164:167], v[108:111], v[188:191], v[164:167]
    s_add_u32 s45, s43, 0
    s_waitcnt lgkmcnt(6)
    v_mfma_f32_16x16x32_bf16 v[160:163], v[112:115], v[192:195], v[160:163]
    ds_read_b128 v[176:179], v8 offset:14976
    buffer_store_dwordx4 v[132:135], v253, s[24:27], s45 offen sc1
    v_mfma_f32_16x16x32_bf16 v[164:167], v[116:119], v[192:195], v[164:167]
    v_cvt_pk_bf16_f32 v152, v152, v153
    s_waitcnt lgkmcnt(6)
    v_mfma_f32_16x16x32_bf16 v[160:163], v[120:123], v[196:199], v[160:163]
    ds_read_b128 v[180:183], v8 offset:15040
    v_cvt_pk_bf16_f32 v153, v154, v155
    v_mfma_f32_16x16x32_bf16 v[164:167], v[124:127], v[196:199], v[164:167]
    ds_write_b64 v9, v[152:153] offset:3840
    s_waitcnt lgkmcnt(6)
    v_mfma_f32_16x16x32_bf16 v[168:171], v[16:19], v[200:203], 0
    ds_read_b128 v[184:187], v8 offset:15104
    v_cvt_pk_bf16_f32 v156, v156, v157
    v_mfma_f32_16x16x32_bf16 v[172:175], v[20:23], v[200:203], 0
    v_cvt_pk_bf16_f32 v157, v158, v159
    s_waitcnt lgkmcnt(5)
    v_mfma_f32_16x16x32_bf16 v[168:171], v[24:27], v[204:207], v[168:171]
    ds_read_b128 v[188:191], v8 offset:15168
    ds_write_b64 v9, v[156:157] offset:3872
    v_mfma_f32_16x16x32_bf16 v[172:175], v[28:31], v[204:207], v[172:175]
    ds_read_b128 v[148:151], v252 offset:2560
    s_waitcnt lgkmcnt(6)
    v_mfma_f32_16x16x32_bf16 v[168:171], v[32:35], v[176:179], v[168:171]
    ds_read_b128 v[192:195], v8 offset:15232
    s_add_u32 s45, s43, 14336
    v_mfma_f32_16x16x32_bf16 v[172:175], v[36:39], v[176:179], v[172:175]
    buffer_store_dwordx4 v[140:143], v253, s[24:27], s45 offen sc1
    s_waitcnt lgkmcnt(6)
    v_mfma_f32_16x16x32_bf16 v[168:171], v[40:43], v[180:183], v[168:171]
    ds_read_b128 v[196:199], v8 offset:15296
    s_add_u32 s45, s43, 28672
    v_mfma_f32_16x16x32_bf16 v[172:175], v[44:47], v[180:183], v[172:175]
    s_waitcnt lgkmcnt(3)
    ds_read_b128 v[156:159], v252 offset:3840
    v_mfma_f32_16x16x32_bf16 v[168:171], v[48:51], v[184:187], v[168:171]
    ds_read_b128 v[200:203], v8 offset:15360
    v_mfma_f32_16x16x32_bf16 v[172:175], v[52:55], v[184:187], v[172:175]
    v_mfma_f32_16x16x32_bf16 v[168:171], v[56:59], v[188:191], v[168:171]
    ds_read_b128 v[204:207], v8 offset:15424
    s_waitcnt lgkmcnt(5)
    buffer_store_dwordx4 v[148:151], v253, s[24:27], s45 offen sc1
    v_mfma_f32_16x16x32_bf16 v[172:175], v[60:63], v[188:191], v[172:175]
    s_add_u32 s45, s43, 43008
    s_waitcnt lgkmcnt(4)
    v_mfma_f32_16x16x32_bf16 v[168:171], v[64:67], v[192:195], v[168:171]
    ds_read_b128 v[176:179], v8 offset:15488
    v_mfma_f32_16x16x32_bf16 v[172:175], v[68:71], v[192:195], v[172:175]
    s_waitcnt lgkmcnt(4)
    v_mfma_f32_16x16x32_bf16 v[168:171], v[72:75], v[196:199], v[168:171]
    ds_read_b128 v[180:183], v8 offset:15552
    s_waitcnt lgkmcnt(4)
    buffer_store_dwordx4 v[156:159], v253, s[24:27], s45 offen sc1
    v_mfma_f32_16x16x32_bf16 v[172:175], v[76:79], v[196:199], v[172:175]
    v_cvt_pk_bf16_f32 v160, v160, v161
    s_waitcnt lgkmcnt(3)
    v_mfma_f32_16x16x32_bf16 v[168:171], v[80:83], v[200:203], v[168:171]
    ds_read_b128 v[184:187], v8 offset:15616
    v_cvt_pk_bf16_f32 v161, v162, v163
    v_mfma_f32_16x16x32_bf16 v[172:175], v[84:87], v[200:203], v[172:175]
    ds_write_b64 v9, v[160:161] offset:0
    s_waitcnt lgkmcnt(4)
    v_mfma_f32_16x16x32_bf16 v[168:171], v[88:91], v[204:207], v[168:171]
    ds_read_b128 v[188:191], v8 offset:15680
    v_cvt_pk_bf16_f32 v164, v164, v165
    v_mfma_f32_16x16x32_bf16 v[172:175], v[92:95], v[204:207], v[172:175]
    v_cvt_pk_bf16_f32 v165, v166, v167
    s_waitcnt lgkmcnt(4)
    v_mfma_f32_16x16x32_bf16 v[168:171], v[96:99], v[176:179], v[168:171]
    ds_read_b128 v[192:195], v8 offset:29696
    ds_write_b64 v9, v[164:165] offset:32
    v_mfma_f32_16x16x32_bf16 v[172:175], v[100:103], v[176:179], v[172:175]
    s_waitcnt lgkmcnt(5)
    v_mfma_f32_16x16x32_bf16 v[168:171], v[104:107], v[180:183], v[168:171]
    ds_read_b128 v[196:199], v8 offset:29760
    v_mfma_f32_16x16x32_bf16 v[172:175], v[108:111], v[180:183], v[172:175]
    s_waitcnt lgkmcnt(5)
    v_mfma_f32_16x16x32_bf16 v[168:171], v[112:115], v[184:187], v[168:171]
    ds_read_b128 v[200:203], v8 offset:29824
    v_mfma_f32_16x16x32_bf16 v[172:175], v[116:119], v[184:187], v[172:175]
    s_waitcnt lgkmcnt(2)
    ds_read_b128 v[164:167], v252 offset:0
    v_mfma_f32_16x16x32_bf16 v[168:171], v[120:123], v[188:191], v[168:171]
    ds_read_b128 v[204:207], v8 offset:29888
    s_add_u32 s45, s43, 57344
    v_mfma_f32_16x16x32_bf16 v[172:175], v[124:127], v[188:191], v[172:175]
    v_mfma_f32_16x16x32_bf16 v[208:211], v[16:19], v[192:195], 0
    ds_read_b128 v[176:179], v8 offset:29952
    v_mfma_f32_16x16x32_bf16 v[212:215], v[20:23], v[192:195], 0
    s_waitcnt lgkmcnt(4)
    v_mfma_f32_16x16x32_bf16 v[208:211], v[24:27], v[196:199], v[208:211]
    ds_read_b128 v[180:183], v8 offset:30016
    v_mfma_f32_16x16x32_bf16 v[212:215], v[28:31], v[196:199], v[212:215]
    s_waitcnt lgkmcnt(3)
    buffer_store_dwordx4 v[164:167], v253, s[24:27], s45 offen sc1
    v_mfma_f32_16x16x32_bf16 v[208:211], v[32:35], v[200:203], v[208:211]
    ds_read_b128 v[184:187], v8 offset:30080
    v_mfma_f32_16x16x32_bf16 v[212:215], v[36:39], v[200:203], v[212:215]
    s_waitcnt lgkmcnt(3)
    v_mfma_f32_16x16x32_bf16 v[208:211], v[40:43], v[204:207], v[208:211]
    ds_read_b128 v[188:191], v8 offset:30144
    v_cvt_pk_bf16_f32 v168, v168, v169
    v_mfma_f32_16x16x32_bf16 v[212:215], v[44:47], v[204:207], v[212:215]
    v_cvt_pk_bf16_f32 v169, v170, v171
    s_waitcnt lgkmcnt(3)
    v_mfma_f32_16x16x32_bf16 v[208:211], v[48:51], v[176:179], v[208:211]
    ds_read_b128 v[192:195], v8 offset:30208
    ds_write_b64 v9, v[168:169] offset:1280
    v_mfma_f32_16x16x32_bf16 v[212:215], v[52:55], v[176:179], v[212:215]
    v_cvt_pk_bf16_f32 v172, v172, v173
    s_waitcnt lgkmcnt(4)
    v_mfma_f32_16x16x32_bf16 v[208:211], v[56:59], v[180:183], v[208:211]
    ds_read_b128 v[196:199], v8 offset:30272
    v_cvt_pk_bf16_f32 v173, v174, v175
    v_mfma_f32_16x16x32_bf16 v[212:215], v[60:63], v[180:183], v[212:215]
    ds_write_b64 v9, v[172:173] offset:1312
    s_waitcnt lgkmcnt(5)
    v_mfma_f32_16x16x32_bf16 v[208:211], v[64:67], v[184:187], v[208:211]
    ds_read_b128 v[200:203], v8 offset:30336
    v_mfma_f32_16x16x32_bf16 v[212:215], v[68:71], v[184:187], v[212:215]
    s_waitcnt lgkmcnt(5)
    v_mfma_f32_16x16x32_bf16 v[208:211], v[72:75], v[188:191], v[208:211]
    ds_read_b128 v[204:207], v8 offset:30400
    v_mfma_f32_16x16x32_bf16 v[212:215], v[76:79], v[188:191], v[212:215]
    s_waitcnt lgkmcnt(5)
    v_mfma_f32_16x16x32_bf16 v[208:211], v[80:83], v[192:195], v[208:211]
    ds_read_b128 v[176:179], v8 offset:30464
    s_waitcnt lgkmcnt(3)
    ds_read_b128 v[172:175], v252 offset:1280
    v_mfma_f32_16x16x32_bf16 v[212:215], v[84:87], v[192:195], v[212:215]
    s_add_u32 s45, s43, 71680
    v_mfma_f32_16x16x32_bf16 v[208:211], v[88:91], v[196:199], v[208:211]
    ds_read_b128 v[180:183], v8 offset:30528
    v_mfma_f32_16x16x32_bf16 v[212:215], v[92:95], v[196:199], v[212:215]
    s_waitcnt lgkmcnt(4)
    v_mfma_f32_16x16x32_bf16 v[208:211], v[96:99], v[200:203], v[208:211]
    ds_read_b128 v[184:187], v8 offset:44544
    v_mfma_f32_16x16x32_bf16 v[212:215], v[100:103], v[200:203], v[212:215]
    s_waitcnt lgkmcnt(4)
    v_mfma_f32_16x16x32_bf16 v[208:211], v[104:107], v[204:207], v[208:211]
    ds_read_b128 v[188:191], v8 offset:44608
    s_waitcnt lgkmcnt(3)
    buffer_store_dwordx4 v[172:175], v253, s[24:27], s45 offen sc1
    v_mfma_f32_16x16x32_bf16 v[212:215], v[108:111], v[204:207], v[212:215]
    v_mfma_f32_16x16x32_bf16 v[208:211], v[112:115], v[176:179], v[208:211]
    ds_read_b128 v[192:195], v8 offset:44672
    v_mfma_f32_16x16x32_bf16 v[212:215], v[116:119], v[176:179], v[212:215]
    s_waitcnt lgkmcnt(3)
    v_mfma_f32_16x16x32_bf16 v[208:211], v[120:123], v[180:183], v[208:211]
    ds_read_b128 v[196:199], v8 offset:44736
    v_mfma_f32_16x16x32_bf16 v[212:215], v[124:127], v[180:183], v[212:215]
    s_waitcnt lgkmcnt(3)
    v_mfma_f32_16x16x32_bf16 v[216:219], v[16:19], v[184:187], 0
    ds_read_b128 v[200:203], v8 offset:44800
    v_mfma_f32_16x16x32_bf16 v[220:223], v[20:23], v[184:187], 0
    s_waitcnt lgkmcnt(3)
    v_mfma_f32_16x16x32_bf16 v[216:219], v[24:27], v[188:191], v[216:219]
    ds_read_b128 v[204:207], v8 offset:44864
    v_mfma_f32_16x16x32_bf16 v[220:223], v[28:31], v[188:191], v[220:223]
    s_waitcnt lgkmcnt(3)
    v_mfma_f32_16x16x32_bf16 v[216:219], v[32:35], v[192:195], v[216:219]
    ds_read_b128 v[176:179], v8 offset:44928
    v_mfma_f32_16x16x32_bf16 v[220:223], v[36:39], v[192:195], v[220:223]
    s_waitcnt lgkmcnt(3)
    v_mfma_f32_16x16x32_bf16 v[216:219], v[40:43], v[196:199], v[216:219]
    ds_read_b128 v[180:183], v8 offset:44992
    v_cvt_pk_bf16_f32 v208, v208, v209
    v_mfma_f32_16x16x32_bf16 v[220:223], v[44:47], v[196:199], v[220:223]
    v_cvt_pk_bf16_f32 v209, v210, v211
    s_waitcnt lgkmcnt(3)
    v_mfma_f32_16x16x32_bf16 v[216:219], v[48:51], v[200:203], v[216:219]
    ds_read_b128 v[184:187], v8 offset:45056
    ds_write_b64 v9, v[208:209] offset:2560
    v_mfma_f32_16x16x32_bf16 v[220:223], v[52:55], v[200:203], v[220:223]
    v_cvt_pk_bf16_f32 v212, v212, v213
    s_waitcnt lgkmcnt(4)
    v_mfma_f32_16x16x32_bf16 v[216:219], v[56:59], v[204:207], v[216:219]
    ds_read_b128 v[188:191], v8 offset:45120
    v_cvt_pk_bf16_f32 v213, v214, v215
    v_mfma_f32_16x16x32_bf16 v[220:223], v[60:63], v[204:207], v[220:223]
    ds_write_b64 v9, v[212:213] offset:2592
    s_waitcnt lgkmcnt(5)
    v_mfma_f32_16x16x32_bf16 v[216:219], v[64:67], v[176:179], v[216:219]
    ds_read_b128 v[192:195], v8 offset:45184
    v_mfma_f32_16x16x32_bf16 v[220:223], v[68:71], v[176:179], v[220:223]
    s_waitcnt lgkmcnt(5)
    v_mfma_f32_16x16x32_bf16 v[216:219], v[72:75], v[180:183], v[216:219]
    ds_read_b128 v[196:199], v8 offset:45248
    v_mfma_f32_16x16x32_bf16 v[220:223], v[76:79], v[180:183], v[220:223]
    s_waitcnt lgkmcnt(5)
    v_mfma_f32_16x16x32_bf16 v[216:219], v[80:83], v[184:187], v[216:219]
    ds_read_b128 v[200:203], v8 offset:45312
    s_waitcnt lgkmcnt(3)
    ds_read_b128 v[212:215], v252 offset:2560
    v_mfma_f32_16x16x32_bf16 v[220:223], v[84:87], v[184:187], v[220:223]
    s_add_u32 s45, s43, 86016
    v_mfma_f32_16x16x32_bf16 v[216:219], v[88:91], v[188:191], v[216:219]
    ds_read_b128 v[204:207], v8 offset:45376
    v_mfma_f32_16x16x32_bf16 v[220:223], v[92:95], v[188:191], v[220:223]
    s_waitcnt lgkmcnt(4)
    v_mfma_f32_16x16x32_bf16 v[216:219], v[96:99], v[192:195], v[216:219]
    v_mfma_f32_16x16x32_bf16 v[220:223], v[100:103], v[192:195], v[220:223]
    s_waitcnt lgkmcnt(3)
    v_mfma_f32_16x16x32_bf16 v[216:219], v[104:107], v[196:199], v[216:219]
    s_waitcnt lgkmcnt(1)
    buffer_store_dwordx4 v[212:215], v253, s[24:27], s45 offen sc1
    v_mfma_f32_16x16x32_bf16 v[220:223], v[108:111], v[196:199], v[220:223]
    v_mfma_f32_16x16x32_bf16 v[216:219], v[112:115], v[200:203], v[216:219]
    v_mfma_f32_16x16x32_bf16 v[220:223], v[116:119], v[200:203], v[220:223]
    s_waitcnt lgkmcnt(0)
    v_mfma_f32_16x16x32_bf16 v[216:219], v[120:123], v[204:207], v[216:219]
    v_mfma_f32_16x16x32_bf16 v[220:223], v[124:127], v[204:207], v[220:223]
    s_nop 7
    v_cvt_pk_bf16_f32 v216, v216, v217
    v_cvt_pk_bf16_f32 v217, v218, v219
    ds_write_b64 v9, v[216:217] offset:3840
    v_cvt_pk_bf16_f32 v220, v220, v221
    v_cvt_pk_bf16_f32 v221, v222, v223
    ds_write_b64 v9, v[220:221] offset:3872
    s_waitcnt lgkmcnt(0)
    ds_read_b128 v[220:223], v252 offset:3840
    s_add_u32 s45, s43, 100352
    s_waitcnt lgkmcnt(0)
    buffer_store_dwordx4 v[220:223], v253, s[24:27], s45 offen sc1
    s_branch L_fin
L_w7:
    s_waitcnt lgkmcnt(0)
    s_waitcnt vmcnt(14)
    s_barrier
    s_add_u32 m0, 147456, 0
    s_add_u32 s45, s42, 57344
    buffer_load_dwordx4 v5, s[20:23], s45 offen offset:0 lds
    buffer_load_dwordx4 v6, s[20:23], s45 offen offset:1024 lds
    buffer_load_dwordx4 v7, s[20:23], s45 offen offset:2048 lds
    buffer_load_dwordx4 v8, s[20:23], s45 offen offset:3072 lds
    s_add_u32 m0, 151552, 0
    s_add_u32 s45, s42, 57344
    buffer_load_dwordx4 v9, s[20:23], s45 offen offset:0 lds
    buffer_load_dwordx4 v252, s[20:23], s45 offen offset:1024 lds
    buffer_load_dwordx4 v253, s[20:23], s45 offen offset:2048 lds
    s_add_u32 m0, 154624, 0
    s_add_u32 s45, s42, 60928
    buffer_load_dwordx4 v5, s[20:23], s45 offen offset:0 lds
    buffer_load_dwordx4 v6, s[20:23], s45 offen offset:1024 lds
    buffer_load_dwordx4 v7, s[20:23], s45 offen offset:2048 lds
    buffer_load_dwordx4 v8, s[20:23], s45 offen offset:3072 lds
    s_add_u32 m0, 158720, 0
    s_add_u32 s45, s42, 60928
    buffer_load_dwordx4 v9, s[20:23], s45 offen offset:0 lds
    buffer_load_dwordx4 v252, s[20:23], s45 offen offset:1024 lds
    buffer_load_dwordx4 v253, s[20:23], s45 offen offset:2048 lds
    s_waitcnt vmcnt(14)
    s_barrier
    s_add_u32 m0, 118784, 0
    s_add_u32 s45, s42, 86016
    buffer_load_dwordx4 v5, s[20:23], s45 offen offset:0 lds
    buffer_load_dwordx4 v6, s[20:23], s45 offen offset:1024 lds
    buffer_load_dwordx4 v7, s[20:23], s45 offen offset:2048 lds
    buffer_load_dwordx4 v8, s[20:23], s45 offen offset:3072 lds
    s_add_u32 m0, 122880, 0
    s_add_u32 s45, s42, 86016
    buffer_load_dwordx4 v9, s[20:23], s45 offen offset:0 lds
    buffer_load_dwordx4 v252, s[20:23], s45 offen offset:1024 lds
    buffer_load_dwordx4 v253, s[20:23], s45 offen offset:2048 lds
    s_add_u32 m0, 125952, 0
    s_add_u32 s45, s42, 89600
    buffer_load_dwordx4 v5, s[20:23], s45 offen offset:0 lds
    buffer_load_dwordx4 v6, s[20:23], s45 offen offset:1024 lds
    buffer_load_dwordx4 v7, s[20:23], s45 offen offset:2048 lds
    buffer_load_dwordx4 v8, s[20:23], s45 offen offset:3072 lds
    s_add_u32 m0, 130048, 0
    s_add_u32 s45, s42, 89600
    buffer_load_dwordx4 v9, s[20:23], s45 offen offset:0 lds
    buffer_load_dwordx4 v252, s[20:23], s45 offen offset:1024 lds
    buffer_load_dwordx4 v253, s[20:23], s45 offen offset:2048 lds
    s_waitcnt vmcnt(14)
    s_barrier
    s_add_u32 m0, 133120, 0
    s_add_u32 s45, s42, 114688
    buffer_load_dwordx4 v5, s[20:23], s45 offen offset:0 lds
    buffer_load_dwordx4 v6, s[20:23], s45 offen offset:1024 lds
    buffer_load_dwordx4 v7, s[20:23], s45 offen offset:2048 lds
    buffer_load_dwordx4 v8, s[20:23], s45 offen offset:3072 lds
    s_add_u32 m0, 137216, 0
    s_add_u32 s45, s42, 114688
    buffer_load_dwordx4 v9, s[20:23], s45 offen offset:0 lds
    buffer_load_dwordx4 v252, s[20:23], s45 offen offset:1024 lds
    buffer_load_dwordx4 v253, s[20:23], s45 offen offset:2048 lds
    s_add_u32 m0, 140288, 0
    s_add_u32 s45, s42, 118272
    buffer_load_dwordx4 v5, s[20:23], s45 offen offset:0 lds
    buffer_load_dwordx4 v6, s[20:23], s45 offen offset:1024 lds
    buffer_load_dwordx4 v7, s[20:23], s45 offen offset:2048 lds
    buffer_load_dwordx4 v8, s[20:23], s45 offen offset:3072 lds
    s_add_u32 m0, 144384, 0
    s_add_u32 s45, s42, 118272
    buffer_load_dwordx4 v9, s[20:23], s45 offen offset:0 lds
    buffer_load_dwordx4 v252, s[20:23], s45 offen offset:1024 lds
    buffer_load_dwordx4 v253, s[20:23], s45 offen offset:2048 lds
    s_waitcnt vmcnt(14)
    s_barrier
    s_add_u32 m0, 147456, 0
    s_add_u32 s45, s42, 143360
    buffer_load_dwordx4 v5, s[20:23], s45 offen offset:0 lds
    buffer_load_dwordx4 v6, s[20:23], s45 offen offset:1024 lds
    buffer_load_dwordx4 v7, s[20:23], s45 offen offset:2048 lds
    buffer_load_dwordx4 v8, s[20:23], s45 offen offset:3072 lds
    s_add_u32 m0, 151552, 0
    s_add_u32 s45, s42, 143360
    buffer_load_dwordx4 v9, s[20:23], s45 offen offset:0 lds
    buffer_load_dwordx4 v252, s[20:23], s45 offen offset:1024 lds
    buffer_load_dwordx4 v253, s[20:23], s45 offen offset:2048 lds
    s_add_u32 m0, 154624, 0
    s_add_u32 s45, s42, 146944
    buffer_load_dwordx4 v5, s[20:23], s45 offen offset:0 lds
    buffer_load_dwordx4 v6, s[20:23], s45 offen offset:1024 lds
    buffer_load_dwordx4 v7, s[20:23], s45 offen offset:2048 lds
    buffer_load_dwordx4 v8, s[20:23], s45 offen offset:3072 lds
    s_add_u32 m0, 158720, 0
    s_add_u32 s45, s42, 146944
    buffer_load_dwordx4 v9, s[20:23], s45 offen offset:0 lds
    buffer_load_dwordx4 v252, s[20:23], s45 offen offset:1024 lds
    buffer_load_dwordx4 v253, s[20:23], s45 offen offset:2048 lds
    s_waitcnt vmcnt(14)
    s_barrier
    s_add_u32 m0, 118784, 0
    s_add_u32 s45, s42, 172032
    buffer_load_dwordx4 v5, s[20:23], s45 offen offset:0 lds
    buffer_load_dwordx4 v6, s[20:23], s45 offen offset:1024 lds
    buffer_load_dwordx4 v7, s[20:23], s45 offen offset:2048 lds
    buffer_load_dwordx4 v8, s[20:23], s45 offen offset:3072 lds
    s_add_u32 m0, 122880, 0
    s_add_u32 s45, s42, 172032
    buffer_load_dwordx4 v9, s[20:23], s45 offen offset:0 lds
    buffer_load_dwordx4 v252, s[20:23], s45 offen offset:1024 lds
    buffer_load_dwordx4 v253, s[20:23], s45 offen offset:2048 lds
    s_add_u32 m0, 125952, 0
    s_add_u32 s45, s42, 175616
    buffer_load_dwordx4 v5, s[20:23], s45 offen offset:0 lds
    buffer_load_dwordx4 v6, s[20:23], s45 offen offset:1024 lds
    buffer_load_dwordx4 v7, s[20:23], s45 offen offset:2048 lds
    buffer_load_dwordx4 v8, s[20:23], s45 offen offset:3072 lds
    s_add_u32 m0, 130048, 0
    s_add_u32 s45, s42, 175616
    buffer_load_dwordx4 v9, s[20:23], s45 offen offset:0 lds
    buffer_load_dwordx4 v252, s[20:23], s45 offen offset:1024 lds
    buffer_load_dwordx4 v253, s[20:23], s45 offen offset:2048 lds
    s_waitcnt vmcnt(14)
    s_barrier
    s_add_u32 m0, 133120, 0
    s_add_u32 s45, s42, 200704
    buffer_load_dwordx4 v5, s[20:23], s45 offen offset:0 lds
    buffer_load_dwordx4 v6, s[20:23], s45 offen offset:1024 lds
    buffer_load_dwordx4 v7, s[20:23], s45 offen offset:2048 lds
    buffer_load_dwordx4 v8, s[20:23], s45 offen offset:3072 lds
    s_add_u32 m0, 137216, 0
    s_add_u32 s45, s42, 200704
    buffer_load_dwordx4 v9, s[20:23], s45 offen offset:0 lds
    buffer_load_dwordx4 v252, s[20:23], s45 offen offset:1024 lds
    buffer_load_dwordx4 v253, s[20:23], s45 offen offset:2048 lds
    s_add_u32 m0, 140288, 0
    s_add_u32 s45, s42, 204288
    buffer_load_dwordx4 v5, s[20:23], s45 offen offset:0 lds
    buffer_load_dwordx4 v6, s[20:23], s45 offen offset:1024 lds
    buffer_load_dwordx4 v7, s[20:23], s45 offen offset:2048 lds
    buffer_load_dwordx4 v8, s[20:23], s45 offen offset:3072 lds
    s_add_u32 m0, 144384, 0
    s_add_u32 s45, s42, 204288
    buffer_load_dwordx4 v9, s[20:23], s45 offen offset:0 lds
    buffer_load_dwordx4 v252, s[20:23], s45 offen offset:1024 lds
    buffer_load_dwordx4 v253, s[20:23], s45 offen offset:2048 lds
    s_waitcnt vmcnt(14)
    s_barrier
    s_add_u32 m0, 147456, 0
    s_add_u32 s45, s42, 229376
    buffer_load_dwordx4 v5, s[20:23], s45 offen offset:0 lds
    buffer_load_dwordx4 v6, s[20:23], s45 offen offset:1024 lds
    buffer_load_dwordx4 v7, s[20:23], s45 offen offset:2048 lds
    buffer_load_dwordx4 v8, s[20:23], s45 offen offset:3072 lds
    s_add_u32 m0, 151552, 0
    s_add_u32 s45, s42, 229376
    buffer_load_dwordx4 v9, s[20:23], s45 offen offset:0 lds
    buffer_load_dwordx4 v252, s[20:23], s45 offen offset:1024 lds
    buffer_load_dwordx4 v253, s[20:23], s45 offen offset:2048 lds
    s_add_u32 m0, 154624, 0
    s_add_u32 s45, s42, 232960
    buffer_load_dwordx4 v5, s[20:23], s45 offen offset:0 lds
    buffer_load_dwordx4 v6, s[20:23], s45 offen offset:1024 lds
    buffer_load_dwordx4 v7, s[20:23], s45 offen offset:2048 lds
    buffer_load_dwordx4 v8, s[20:23], s45 offen offset:3072 lds
    s_add_u32 m0, 158720, 0
    s_add_u32 s45, s42, 232960
    buffer_load_dwordx4 v9, s[20:23], s45 offen offset:0 lds
    buffer_load_dwordx4 v252, s[20:23], s45 offen offset:1024 lds
    buffer_load_dwordx4 v253, s[20:23], s45 offen offset:2048 lds
    s_waitcnt vmcnt(14)
    s_barrier
    s_add_u32 m0, 118784, 0
    s_add_u32 s45, s42, 258048
    buffer_load_dwordx4 v5, s[20:23], s45 offen offset:0 lds
    buffer_load_dwordx4 v6, s[20:23], s45 offen offset:1024 lds
    buffer_load_dwordx4 v7, s[20:23], s45 offen offset:2048 lds
    buffer_load_dwordx4 v8, s[20:23], s45 offen offset:3072 lds
    s_add_u32 m0, 122880, 0
    s_add_u32 s45, s42, 258048
    buffer_load_dwordx4 v9, s[20:23], s45 offen offset:0 lds
    buffer_load_dwordx4 v252, s[20:23], s45 offen offset:1024 lds
    buffer_load_dwordx4 v253, s[20:23], s45 offen offset:2048 lds
    s_add_u32 m0, 125952, 0
    s_add_u32 s45, s42, 261632
    buffer_load_dwordx4 v5, s[20:23], s45 offen offset:0 lds
    buffer_load_dwordx4 v6, s[20:23], s45 offen offset:1024 lds
    buffer_load_dwordx4 v7, s[20:23], s45 offen offset:2048 lds
    buffer_load_dwordx4 v8, s[20:23], s45 offen offset:3072 lds
    s_add_u32 m0, 130048, 0
    s_add_u32 s45, s42, 261632
    buffer_load_dwordx4 v9, s[20:23], s45 offen offset:0 lds
    buffer_load_dwordx4 v252, s[20:23], s45 offen offset:1024 lds
    buffer_load_dwordx4 v253, s[20:23], s45 offen offset:2048 lds
    s_waitcnt vmcnt(14)
    s_barrier
    s_add_u32 m0, 133120, 0
    s_add_u32 s45, s42, 286720
    buffer_load_dwordx4 v5, s[20:23], s45 offen offset:0 lds
    buffer_load_dwordx4 v6, s[20:23], s45 offen offset:1024 lds
    buffer_load_dwordx4 v7, s[20:23], s45 offen offset:2048 lds
    buffer_load_dwordx4 v8, s[20:23], s45 offen offset:3072 lds
    s_add_u32 m0, 137216, 0
    s_add_u32 s45, s42, 286720
    buffer_load_dwordx4 v9, s[20:23], s45 offen offset:0 lds
    buffer_load_dwordx4 v252, s[20:23], s45 offen offset:1024 lds
    buffer_load_dwordx4 v253, s[20:23], s45 offen offset:2048 lds
    s_add_u32 m0, 140288, 0
    s_add_u32 s45, s42, 290304
    buffer_load_dwordx4 v5, s[20:23], s45 offen offset:0 lds
    buffer_load_dwordx4 v6, s[20:23], s45 offen offset:1024 lds
    buffer_load_dwordx4 v7, s[20:23], s45 offen offset:2048 lds
    buffer_load_dwordx4 v8, s[20:23], s45 offen offset:3072 lds
    s_add_u32 m0, 144384, 0
    s_add_u32 s45, s42, 290304
    buffer_load_dwordx4 v9, s[20:23], s45 offen offset:0 lds
    buffer_load_dwordx4 v252, s[20:23], s45 offen offset:1024 lds
    buffer_load_dwordx4 v253, s[20:23], s45 offen offset:2048 lds
    s_waitcnt vmcnt(14)
    s_barrier
    s_add_u32 m0, 147456, 0
    s_add_u32 s45, s42, 315392
    buffer_load_dwordx4 v5, s[20:23], s45 offen offset:0 lds
    buffer_load_dwordx4 v6, s[20:23], s45 offen offset:1024 lds
    buffer_load_dwordx4 v7, s[20:23], s45 offen offset:2048 lds
    buffer_load_dwordx4 v8, s[20:23], s45 offen offset:3072 lds
    s_add_u32 m0, 151552, 0
    s_add_u32 s45, s42, 315392
    buffer_load_dwordx4 v9, s[20:23], s45 offen offset:0 lds
    buffer_load_dwordx4 v252, s[20:23], s45 offen offset:1024 lds
    buffer_load_dwordx4 v253, s[20:23], s45 offen offset:2048 lds
    s_add_u32 m0, 154624, 0
    s_add_u32 s45, s42, 318976
    buffer_load_dwordx4 v5, s[20:23], s45 offen offset:0 lds
    buffer_load_dwordx4 v6, s[20:23], s45 offen offset:1024 lds
    buffer_load_dwordx4 v7, s[20:23], s45 offen offset:2048 lds
    buffer_load_dwordx4 v8, s[20:23], s45 offen offset:3072 lds
    s_add_u32 m0, 158720, 0
    s_add_u32 s45, s42, 318976
    buffer_load_dwordx4 v9, s[20:23], s45 offen offset:0 lds
    buffer_load_dwordx4 v252, s[20:23], s45 offen offset:1024 lds
    buffer_load_dwordx4 v253, s[20:23], s45 offen offset:2048 lds
    s_waitcnt vmcnt(14)
    s_barrier
    s_add_u32 m0, 118784, 0
    s_add_u32 s45, s42, 344064
    buffer_load_dwordx4 v5, s[20:23], s45 offen offset:0 lds
    buffer_load_dwordx4 v6, s[20:23], s45 offen offset:1024 lds
    buffer_load_dwordx4 v7, s[20:23], s45 offen offset:2048 lds
    buffer_load_dwordx4 v8, s[20:23], s45 offen offset:3072 lds
    s_add_u32 m0, 122880, 0
    s_add_u32 s45, s42, 344064
    buffer_load_dwordx4 v9, s[20:23], s45 offen offset:0 lds
    buffer_load_dwordx4 v252, s[20:23], s45 offen offset:1024 lds
    buffer_load_dwordx4 v253, s[20:23], s45 offen offset:2048 lds
    s_add_u32 m0, 125952, 0
    s_add_u32 s45, s42, 347648
    buffer_load_dwordx4 v5, s[20:23], s45 offen offset:0 lds
    buffer_load_dwordx4 v6, s[20:23], s45 offen offset:1024 lds
    buffer_load_dwordx4 v7, s[20:23], s45 offen offset:2048 lds
    buffer_load_dwordx4 v8, s[20:23], s45 offen offset:3072 lds
    s_add_u32 m0, 130048, 0
    s_add_u32 s45, s42, 347648
    buffer_load_dwordx4 v9, s[20:23], s45 offen offset:0 lds
    buffer_load_dwordx4 v252, s[20:23], s45 offen offset:1024 lds
    buffer_load_dwordx4 v253, s[20:23], s45 offen offset:2048 lds
    s_waitcnt vmcnt(14)
    s_barrier
    s_add_u32 m0, 133120, 0
    s_add_u32 s45, s42, 372736
    buffer_load_dwordx4 v5, s[20:23], s45 offen offset:0 lds
    buffer_load_dwordx4 v6, s[20:23], s45 offen offset:1024 lds
    buffer_load_dwordx4 v7, s[20:23], s45 offen offset:2048 lds
    buffer_load_dwordx4 v8, s[20:23], s45 offen offset:3072 lds
    s_add_u32 m0, 137216, 0
    s_add_u32 s45, s42, 372736
    buffer_load_dwordx4 v9, s[20:23], s45 offen offset:0 lds
    buffer_load_dwordx4 v252, s[20:23], s45 offen offset:1024 lds
    buffer_load_dwordx4 v253, s[20:23], s45 offen offset:2048 lds
    s_add_u32 m0, 140288, 0
    s_add_u32 s45, s42, 376320
    buffer_load_dwordx4 v5, s[20:23], s45 offen offset:0 lds
    buffer_load_dwordx4 v6, s[20:23], s45 offen offset:1024 lds
    buffer_load_dwordx4 v7, s[20:23], s45 offen offset:2048 lds
    buffer_load_dwordx4 v8, s[20:23], s45 offen offset:3072 lds
    s_add_u32 m0, 144384, 0
    s_add_u32 s45, s42, 376320
    buffer_load_dwordx4 v9, s[20:23], s45 offen offset:0 lds
    buffer_load_dwordx4 v252, s[20:23], s45 offen offset:1024 lds
    buffer_load_dwordx4 v253, s[20:23], s45 offen offset:2048 lds
    s_waitcnt vmcnt(14)
    s_barrier
    s_waitcnt vmcnt(0)
    s_barrier
    s_barrier
L_fin:
L_end:
    s_endpgm
.section .rodata,"a"
.p2align 6
.amdhsa_kernel standalone__layernorm_linear__sampling_kernel
  .amdhsa_next_free_vgpr 256
  .amdhsa_next_free_sgpr 64
  .amdhsa_accum_offset 256
  .amdhsa_group_segment_fixed_size 0
  .amdhsa_kernarg_size 56
  .amdhsa_user_sgpr_count 2
  .amdhsa_user_sgpr_kernarg_segment_ptr 1
  .amdhsa_system_sgpr_workgroup_id_x 1
.end_amdhsa_kernel
```
